```python
import torch

def _softmax(x, axis=-1):
    return torch.softmax(x, dim=axis)
def _gelu(x):
    return torch.nn.functional.gelu(x, approximate="tanh")
def _silu(x):
    return torch.nn.functional.silu(x)
def _sigmoid(x):
    return torch.sigmoid(x)
def _layernorm(x, axis=-1, eps=1e-5):
    m = x.mean(dim=axis, keepdim=True)
    v = x.var(dim=axis, keepdim=True, unbiased=False)
    return (x - m) / torch.sqrt(v + eps)
def _scatter_add(tgt, idx, src, axis=0):
    return tgt.clone().index_add_(axis, idx, src)
def _segment_sum(src, seg, n):
    out = torch.zeros((n,) + src.shape[1:], dtype=src.dtype)
    return out.index_add_(0, seg, src)
def _pad(x, pw):
    flat = tuple(v for pair in reversed(pw) for v in pair)
    return torch.nn.functional.pad(x, flat)

kernel_name = 'standalone__qk_norm__prompt'

def setup_inputs():

    _w = (lambda a: (lambda t: t.to(torch.bfloat16) if t.is_floating_point() else t)(torch.as_tensor(a)))
    B, H, S, D = 2, 32, 2048, 640
    Dh = D // H
    return {
        "q": _w((lambda *s: torch.randn(*s, dtype=torch.bfloat16) * 0.05)(B, H, S, Dh)),
        "k": _w((lambda *s: torch.randn(*s, dtype=torch.bfloat16) * 0.05)(B, H, S, Dh)),
        "v": _w((lambda *s: torch.randn(*s, dtype=torch.bfloat16) * 0.8)(B, H, S, Dh)),
        "t": _w(torch.abs((lambda *s: torch.randn(*s, dtype=torch.bfloat16) * 0.8)(H)) + 1.0),
    }

def reference(q, k, v, t):
    eps = 1e-6
    qn = q / (torch.sqrt((q * q).sum(axis=-1, keepdims=True)) + eps)
    kn = k / (torch.sqrt((k * k).sum(axis=-1, keepdims=True)) + eps)
    logits = torch.einsum('bhqd,bhkd->bhqk', qn, kn) * t[None, :, None, None]
    attn = _softmax(logits, axis=-1)
    return torch.einsum('bhqk,bhkd->bhqd', attn, v)
```

```asm
; @launch grid=(256,1,1) block=(512,1,1) lds=102400
.amdgcn_target "amdgcn-amd-amdhsa--gfx950"
.text
.globl standalone__qk_norm__prompt_kernel
.p2align 8
.type standalone__qk_norm__prompt_kernel,@function
standalone__qk_norm__prompt_kernel:
  s_cmp_ge_u32 s2, 256
  s_cbranch_scc1 L_end
  s_load_dwordx4 s[20:23], s[0:1], 0
  s_load_dwordx4 s[24:27], s[0:1], 16
  s_load_dwordx2 s[28:29], s[0:1], 32
  s_and_b32 s30, s2, 7
  s_lshr_b32 s3, s2, 5
  s_lshl_b32 s3, s3, 3
  s_add_u32 s30, s30, s3
  s_lshr_b32 s31, s2, 3
  s_and_b32 s31, s31, 3
  v_and_b32 v1, 63, v0
  v_lshrrev_b32 v14, 6, v0
  s_mul_i32 s35, s30, 81920
  v_readfirstlane_b32 s32, v14
  s_mul_i32 s45, s31, 20480
  s_add_u32 s45, s45, s35
  s_and_b32 s46, s30, 31
  s_lshl_b32 s46, s46, 1
  s_and_b32 s47, s46, 0x7c
  s_lshr_b32 s33, s32, 2
  s_and_b32 s51, s32, 3
  s_lshl_b32 s51, s51, 7
  v_and_b32 v16, 255, v0
  v_mul_u32_u24 v8, 40, v16
  v_and_b32 v14, 31, v1
  v_lshrrev_b32 v15, 5, v1
  v_add_u32 v112, s51, v14
  v_mul_u32_u24 v112, 40, v112
  v_lshl_add_u32 v28, v15, 4, v112
  v_lshl_add_u32 v29, v15, 24, v112
  s_mov_b32 s43, 0
  s_mov_b32 s6, 20480
  s_mov_b32 s7, 0x00020000
  s_mov_b32 s38, 81920
  s_mov_b32 s39, 0x00020000
  s_mov_b32 s14, 81920
  s_mov_b32 s15, 0x00020000
  s_cmp_eq_u32 s33, 0
  s_waitcnt lgkmcnt(0)
  s_cbranch_scc1 L_ld0
  s_add_u32 s4, s20, s45
  s_addc_u32 s5, s21, 0
  buffer_load_dwordx4 v[32:35], v28, s[4:7], 0 offen offset:0
  buffer_load_dwordx2 v[36:37], v29, s[4:7], 0 offen offset:32
  s_add_u32 s36, s24, s35
  s_addc_u32 s37, s25, 0
  s_branch L_ldE
L_ld0:
  s_add_u32 s36, s22, s35
  s_addc_u32 s37, s23, 0
  buffer_load_dwordx4 v[96:99], v8, s[36:39], s43 offen
  buffer_load_dwordx4 v[100:103], v8, s[36:39], s43 offen offset:16
  buffer_load_dwordx2 v[104:105], v8, s[36:39], s43 offen offset:32
  s_add_u32 s12, s24, s35
  s_addc_u32 s13, s25, 0
  buffer_load_dwordx4 v[80:83], v8, s[12:15], 0 offen
  buffer_load_dwordx4 v[84:87], v8, s[12:15], 0 offen offset:16
  buffer_load_dwordx2 v[88:89], v8, s[12:15], 0 offen offset:32
  s_add_u32 s4, s20, s45
  s_addc_u32 s5, s21, 0
L_ldE:
  s_load_dword s34, s[26:27], s47
  s_add_u32 s16, s28, s45
  s_addc_u32 s17, s29, 0
  s_mov_b32 s18, 20480
  s_mov_b32 s19, 0x00020000
  v_and_b32 v13, 0xc0, v0
  v_lshl_add_u32 v13, v13, 1, v1
  v_mul_u32_u24 v13, 40, v13
  s_cmp_eq_u32 s33, 0
  s_cselect_b32 s3, 16, 48
  v_mul_u32_u24 v9, s3, v16
  v_lshlrev_b32 v10, 3, v16
  v_mul_u32_u24 v19, 48, v16
  s_mov_b32 s49, 0x3f803f80
  s_mov_b32 s48, 0x00003f80
  s_cselect_b32 s3, s49, s48
  v_mov_b32 v108, s3
  v_mov_b32 v109, 0
  s_mov_b32 s48, 10240
  s_mov_b32 s49, 12328
  s_cselect_b32 s3, s48, s49
  v_mov_b32 v110, s3
  v_add_u32 v111, v110, v9
  v_add_u32 v110, v110, v10
  s_cselect_b64 vcc, -1, 0
  v_cndmask_b32 v110, v111, v110, vcc
  v_mov_b32 v30, 0
  v_mov_b32 v31, 0
  ds_write_b64 v110, v[108:109] offset:0
  ds_write_b64 v110, v[108:109] offset:24576
  s_nop 1
  v_mfma_f32_32x32x8_bf16 v[136:151], v[30:31], v[30:31], 0
  v_mfma_f32_32x32x8_bf16 v[152:167], v[30:31], v[30:31], 0
  v_mfma_f32_32x32x8_bf16 v[168:183], v[30:31], v[30:31], 0
  v_mfma_f32_32x32x8_bf16 v[184:199], v[30:31], v[30:31], 0
  s_lshl_b32 s3, s33, 9
  v_lshlrev_b32 v5, 4, v14
  v_lshl_add_u32 v5, v15, 12, v5
  v_add_u32 v5, s3, v5
  s_lshl_b32 s3, s33, 8
  s_add_u32 s3, s3, 8192
  v_lshlrev_b32 v6, 3, v14
  v_lshl_add_u32 v6, v15, 11, v6
  v_add_u32 v6, s3, v6
  s_lshl_b32 s3, s33, 5
  s_add_u32 s3, s3, s51
  v_add_u32 v112, s3, v14
  s_xor_b32 s3, s3, 32
  v_add_u32 v113, s3, v14
  v_lshlrev_b32 v114, 13, v15
  v_add_u32 v114, 49152, v114
  v_lshlrev_b32 v115, 12, v15
  v_add_u32 v115, 65536, v115
  v_lshl_add_u32 v21, v112, 4, v114
  v_lshl_add_u32 v20, v113, 4, v114
  v_lshl_add_u32 v23, v112, 3, v115
  v_lshl_add_u32 v22, v113, 3, v115
  s_mul_i32 s3, s33, 1280
  v_add_u32 v28, s3, v28
  v_add_u32 v29, s3, v29
  s_mul_i32 s3, s32, 6656
  s_add_u32 s3, s3, 49152
  v_lshlrev_b32 v112, 4, v1
  v_lshlrev_b32 v113, 2, v1
  v_add_u32 v24, s3, v112
  v_add_u32 v25, s3, v113
  s_xor_b32 s3, s32, 4
  s_mul_i32 s3, s3, 6656
  s_add_u32 s3, s3, 49152
  v_add_u32 v26, s3, v112
  v_add_u32 v27, s3, v113
  v_bfe_u32 v16, v1, 2, 2
  v_lshl_add_u32 v16, v15, 3, v16
  v_mul_u32_u24 v7, 48, v16
  v_and_b32 v16, 3, v1
  v_min_u32 v112, 1, v16
  v_add_u32 v112, 4, v112
  v_and_b32 v113, 16, v1
  v_cmp_ne_u32 vcc, 0, v113
  s_mul_i32 s3, s33, 1536
  s_add_u32 s3, s3, 12288
  v_cndmask_b32 v16, v16, v112, vcc
  v_lshl_add_u32 v7, v16, 3, v7
  v_add_u32 v7, s3, v7
  v_mov_b32 v18, 0xdddd
  v_mov_b32 v2, v5
  v_mov_b32 v3, v6
  v_mov_b32 v4, v7
  s_waitcnt lgkmcnt(0)
  s_and_b32 s46, s46, 2
  s_lshl_b32 s46, s46, 3
  s_lshr_b32 s34, s34, s46
  s_lshl_b32 s34, s34, 16
  v_mov_b32 v17, s34
  v_mul_f32 v17, 0x3fb8aa3b, v17
  v_or_b32 v72, 0x80000000, v17
  v_cvt_pk_bf16_f32 v72, v72, 0
  v_mov_b32 v73, 0
  s_mov_b32 s52, 65536
  v_lshl_add_u32 v12, v0, 3, s52
  ds_write_b64 v12, v[72:73] offset:4096
  s_cmp_lg_u32 s33, 0
  s_cbranch_scc1 L_proV
  v_mov_b32 v11, v9
  v_mov_b32 v12, v10
  s_waitcnt vmcnt(3)
  buffer_load_dwordx4 v[126:129], v28, s[4:7], 0 offen offset:1280
  buffer_load_dwordx2 v[130:131], v29, s[4:7], 0 offen offset:1312
  v_dot2_f32_bf16 v14, v96, v96, 0
  v_dot2_f32_bf16 v15, v97, v97, 0
  v_dot2_f32_bf16 v14, v98, v98, v14
  v_dot2_f32_bf16 v15, v99, v99, v15
  v_dot2_f32_bf16 v14, v100, v100, v14
  v_dot2_f32_bf16 v15, v101, v101, v15
  v_dot2_f32_bf16 v14, v102, v102, v14
  v_dot2_f32_bf16 v15, v103, v103, v15
  v_dot2_f32_bf16 v14, v104, v104, v14
  v_dot2_f32_bf16 v15, v105, v105, v15
  v_lshlrev_b32 v106, 16, v96
  v_and_b32 v107, 0xffff0000, v96
  v_lshlrev_b32 v108, 16, v97
  v_and_b32 v109, 0xffff0000, v97
  v_add_f32 v14, v14, v15
  v_sqrt_f32 v14, v14
  v_lshlrev_b32 v110, 16, v98
  v_and_b32 v111, 0xffff0000, v98
  v_lshlrev_b32 v112, 16, v99
  v_and_b32 v113, 0xffff0000, v99
  v_lshlrev_b32 v114, 16, v100
  v_and_b32 v115, 0xffff0000, v100
  v_add_f32 v14, 0x358637bd, v14
  v_rcp_f32 v16, v14
  v_lshlrev_b32 v116, 16, v101
  v_and_b32 v117, 0xffff0000, v101
  v_lshlrev_b32 v118, 16, v102
  v_and_b32 v119, 0xffff0000, v102
  v_lshlrev_b32 v120, 16, v103
  v_and_b32 v121, 0xffff0000, v103
  v_lshlrev_b32 v122, 16, v104
  v_and_b32 v123, 0xffff0000, v104
  v_lshlrev_b32 v124, 16, v105
  v_and_b32 v125, 0xffff0000, v105
  v_pk_mul_f32 v[106:107], v[106:107], v[16:17] op_sel_hi:[1,0]
  v_pk_mul_f32 v[108:109], v[108:109], v[16:17] op_sel_hi:[1,0]
  v_pk_mul_f32 v[110:111], v[110:111], v[16:17] op_sel_hi:[1,0]
  v_pk_mul_f32 v[112:113], v[112:113], v[16:17] op_sel_hi:[1,0]
  v_pk_mul_f32 v[114:115], v[114:115], v[16:17] op_sel_hi:[1,0]
  v_pk_mul_f32 v[116:117], v[116:117], v[16:17] op_sel_hi:[1,0]
  v_pk_mul_f32 v[118:119], v[118:119], v[16:17] op_sel_hi:[1,0]
  v_pk_mul_f32 v[120:121], v[120:121], v[16:17] op_sel_hi:[1,0]
  v_pk_mul_f32 v[122:123], v[122:123], v[16:17] op_sel_hi:[1,0]
  v_pk_mul_f32 v[124:125], v[124:125], v[16:17] op_sel_hi:[1,0]
  v_cvt_pk_bf16_f32 v96, v106, v107
  v_cvt_pk_bf16_f32 v97, v108, v109
  v_cvt_pk_bf16_f32 v98, v110, v111
  v_cvt_pk_bf16_f32 v99, v112, v113
  v_cvt_pk_bf16_f32 v100, v114, v115
  v_cvt_pk_bf16_f32 v101, v116, v117
  v_cvt_pk_bf16_f32 v102, v118, v119
  v_cvt_pk_bf16_f32 v103, v120, v121
  v_cvt_pk_bf16_f32 v104, v122, v123
  v_cvt_pk_bf16_f32 v105, v124, v125
  ds_write_b128 v11, v[96:99] offset:0
  ds_write_b128 v11, v[100:103] offset:4096
  ds_write_b64 v12, v[104:105] offset:8192
  s_waitcnt vmcnt(2)
  ds_write_b128 v19, v[80:83] offset:12288
  ds_write_b128 v19, v[84:87] offset:12304
  ds_write_b64 v19, v[88:89] offset:12320
  s_and_b32 s3, s34, 0x7fffffff
  s_waitcnt lgkmcnt(0)
  s_barrier
  s_cmp_gt_u32 s3, 0x41800000
  s_cbranch_scc1 L_fallback
L_go0:
  ds_read_b128 v[224:227], v2 offset:0
  ds_read_b64 v[228:229], v3 offset:0
  ds_read_b128 v[206:209], v21 offset:0
  ds_read_b64 v[210:211], v23 offset:0
  ds_read_b128 v[230:233], v2 offset:1024
  ds_read_b64 v[234:235], v3 offset:512
  ds_read_b64_tr_b16 v[236:237], v4 offset:0
  ds_read_b64_tr_b16 v[238:239], v4 offset:192
  ds_read_b64_tr_b16 v[240:241], v4 offset:768
  ds_read_b64_tr_b16 v[242:243], v4 offset:960
  s_waitcnt lgkmcnt(6)
  v_mfma_f32_32x32x8_bf16 v[32:47], v[228:229], v[210:211], 0
  v_mfma_f32_32x32x16_bf16 v[32:47], v[224:227], v[206:209], v[32:47]
  s_waitcnt lgkmcnt(4)
  v_mfma_f32_32x32x8_bf16 v[48:63], v[234:235], v[210:211], 0
  v_mfma_f32_32x32x16_bf16 v[48:63], v[230:233], v[206:209], v[48:63]
  ds_read_b128 v[224:227], v2 offset:2048
  ds_read_b64 v[228:229], v3 offset:1024
  s_nop 7
  s_setprio 3
  s_waitcnt lgkmcnt(0)
  ds_read_b128 v[230:233], v2 offset:3072
  ds_read_b64 v[234:235], v3 offset:1536
  v_exp_f32 v32, v32
  v_exp_f32 v33, v33
  v_exp_f32 v34, v34
  v_exp_f32 v35, v35
  v_exp_f32 v36, v36
  v_exp_f32 v37, v37
  v_exp_f32 v38, v38
  v_exp_f32 v39, v39
  v_mfma_f32_32x32x8_bf16 v[64:79], v[228:229], v[210:211], 0
  v_exp_f32 v40, v40
  v_exp_f32 v41, v41
  v_exp_f32 v42, v42
  v_exp_f32 v43, v43
  v_mfma_f32_32x32x16_bf16 v[64:79], v[224:227], v[206:209], v[64:79]
  v_exp_f32 v44, v44
  v_exp_f32 v45, v45
  v_exp_f32 v46, v46
  v_exp_f32 v47, v47
  s_setprio 2
  s_waitcnt lgkmcnt(0)
  s_waitcnt vmcnt(0)
  v_dot2_f32_bf16 v14, v126, v126, 0
  v_dot2_f32_bf16 v15, v127, v127, 0
  v_dot2_f32_bf16 v14, v128, v128, v14
  v_dot2_f32_bf16 v15, v129, v129, v15
  v_dot2_f32_bf16 v14, v130, v130, v14
  v_dot2_f32_bf16 v15, v131, v131, v15
  v_lshlrev_b32 v106, 16, v126
  v_and_b32 v107, 0xffff0000, v126
  v_lshlrev_b32 v108, 16, v127
  v_and_b32 v109, 0xffff0000, v127
  v_add_f32 v16, v14, v15
  v_add_f32 v15, v14, v15
  v_lshlrev_b32 v110, 16, v128
  v_and_b32 v111, 0xffff0000, v128
  v_permlane32_swap_b32 v16, v15
  v_lshlrev_b32 v112, 16, v129
  v_and_b32 v113, 0xffff0000, v129
  v_add_f32 v14, v16, v15
  v_sqrt_f32 v14, v14
  v_lshlrev_b32 v114, 16, v130
  v_and_b32 v115, 0xffff0000, v130
  v_add_f32 v14, 0x358637bd, v14
  v_rcp_f32 v16, v14
  v_lshlrev_b32 v116, 16, v131
  v_and_b32 v117, 0xffff0000, v131
  v_mul_f32 v16, v16, v17
  s_nop 0
  v_pk_mul_f32 v[106:107], v[106:107], v[16:17] op_sel_hi:[1,0]
  v_pk_mul_f32 v[108:109], v[108:109], v[16:17] op_sel_hi:[1,0]
  v_pk_mul_f32 v[110:111], v[110:111], v[16:17] op_sel_hi:[1,0]
  v_pk_mul_f32 v[112:113], v[112:113], v[16:17] op_sel_hi:[1,0]
  v_pk_mul_f32 v[114:115], v[114:115], v[16:17] op_sel_hi:[1,0]
  v_pk_mul_f32 v[116:117], v[116:117], v[16:17] op_sel_hi:[1,0]
  v_cvt_pk_bf16_f32 v126, v106, v107
  v_cvt_pk_bf16_f32 v127, v108, v109
  v_cvt_pk_bf16_f32 v128, v110, v111
  v_cvt_pk_bf16_f32 v129, v112, v113
  v_cvt_pk_bf16_f32 v130, v114, v115
  v_cvt_pk_bf16_f32 v131, v116, v117
  ds_write_b128 v20, v[126:129]
  s_mov_b32 exec_hi, 0
  ds_write_b64 v22, v[130:131]
  s_mov_b32 exec_hi, -1
  ds_read_b128 v[224:227], v2 offset:0
  ds_read_b64 v[228:229], v3 offset:0
  ds_read_b64_tr_b16 v[244:245], v4 offset:3072
  ds_read_b64_tr_b16 v[246:247], v4 offset:3264
  ds_read_b64_tr_b16 v[248:249], v4 offset:3840
  ds_read_b64_tr_b16 v[250:251], v4 offset:4032
  v_smfmac_f32_32x32x32_bf16 v[152:167], v[236:239], v[32:39], v18
  v_exp_f32 v48, v48
  v_exp_f32 v49, v49
  v_exp_f32 v50, v50
  v_exp_f32 v51, v51
  v_smfmac_f32_32x32x32_bf16 v[152:167], v[240:243], v[40:47], v18
  v_exp_f32 v52, v52
  v_exp_f32 v53, v53
  v_exp_f32 v54, v54
  v_exp_f32 v55, v55
  v_mfma_f32_32x32x8_bf16 v[80:95], v[234:235], v[210:211], 0
  v_exp_f32 v56, v56
  v_exp_f32 v57, v57
  v_exp_f32 v58, v58
  v_exp_f32 v59, v59
  v_mfma_f32_32x32x16_bf16 v[80:95], v[230:233], v[206:209], v[80:95]
  v_exp_f32 v60, v60
  v_exp_f32 v61, v61
  v_exp_f32 v62, v62
  v_exp_f32 v63, v63
  s_setprio 3
  s_waitcnt lgkmcnt(0)
  s_barrier
  ds_read_b128 v[200:203], v20 offset:0
  ds_read_b64 v[204:205], v22 offset:0
  ds_read_b128 v[230:233], v2 offset:1024
  ds_read_b64 v[234:235], v3 offset:512
  ds_read_b64_tr_b16 v[236:237], v4 offset:6144
  ds_read_b64_tr_b16 v[238:239], v4 offset:6336
  ds_read_b64_tr_b16 v[240:241], v4 offset:6912
  ds_read_b64_tr_b16 v[242:243], v4 offset:7104
  v_smfmac_f32_32x32x32_bf16 v[152:167], v[244:247], v[48:55], v18
  v_exp_f32 v64, v64
  v_exp_f32 v65, v65
  v_exp_f32 v66, v66
  v_exp_f32 v67, v67
  s_mov_b32 s43, 10240
  buffer_load_dwordx4 v[96:99], v8, s[36:39], s43 offen
  buffer_load_dwordx4 v[100:103], v8, s[36:39], s43 offen offset:16
  buffer_load_dwordx2 v[104:105], v8, s[36:39], s43 offen offset:32
  v_smfmac_f32_32x32x32_bf16 v[152:167], v[248:251], v[56:63], v18
  v_exp_f32 v68, v68
  v_exp_f32 v69, v69
  v_exp_f32 v70, v70
  v_exp_f32 v71, v71
  s_waitcnt lgkmcnt(0)
  v_mfma_f32_32x32x8_bf16 v[32:47], v[228:229], v[204:205], 0
  v_exp_f32 v72, v72
  v_exp_f32 v73, v73
  v_exp_f32 v74, v74
  v_exp_f32 v75, v75
  v_mfma_f32_32x32x16_bf16 v[32:47], v[224:227], v[200:203], v[32:47]
  v_exp_f32 v76, v76
  v_exp_f32 v77, v77
  v_exp_f32 v78, v78
  v_exp_f32 v79, v79
  s_setprio 3
  s_waitcnt lgkmcnt(0)
  ds_read_b128 v[224:227], v2 offset:2048
  ds_read_b64 v[228:229], v3 offset:1024
  ds_read_b64_tr_b16 v[244:245], v4 offset:9216
  ds_read_b64_tr_b16 v[246:247], v4 offset:9408
  ds_read_b64_tr_b16 v[248:249], v4 offset:9984
  ds_read_b64_tr_b16 v[250:251], v4 offset:10176
  v_smfmac_f32_32x32x32_bf16 v[152:167], v[236:239], v[64:71], v18
  v_exp_f32 v80, v80
  v_exp_f32 v81, v81
  v_exp_f32 v82, v82
  v_exp_f32 v83, v83
  v_smfmac_f32_32x32x32_bf16 v[152:167], v[240:243], v[72:79], v18
  v_exp_f32 v84, v84
  v_exp_f32 v85, v85
  v_exp_f32 v86, v86
  v_exp_f32 v87, v87
  v_mfma_f32_32x32x8_bf16 v[48:63], v[234:235], v[204:205], 0
  v_exp_f32 v88, v88
  v_exp_f32 v89, v89
  v_exp_f32 v90, v90
  v_exp_f32 v91, v91
  v_mfma_f32_32x32x16_bf16 v[48:63], v[230:233], v[200:203], v[48:63]
  v_exp_f32 v92, v92
  v_exp_f32 v93, v93
  v_exp_f32 v94, v94
  v_exp_f32 v95, v95
  s_setprio 2
  s_waitcnt lgkmcnt(0)
  ds_read_b128 v[230:233], v2 offset:3072
  ds_read_b64 v[234:235], v3 offset:1536
  ds_read_b64_tr_b16 v[236:237], v4 offset:0
  ds_read_b64_tr_b16 v[238:239], v4 offset:192
  ds_read_b64_tr_b16 v[240:241], v4 offset:768
  ds_read_b64_tr_b16 v[242:243], v4 offset:960
  v_smfmac_f32_32x32x32_bf16 v[152:167], v[244:247], v[80:87], v18
  v_exp_f32 v32, v32
  v_exp_f32 v33, v33
  v_exp_f32 v34, v34
  v_exp_f32 v35, v35
  v_smfmac_f32_32x32x32_bf16 v[152:167], v[248:251], v[88:95], v18
  v_exp_f32 v36, v36
  v_exp_f32 v37, v37
  v_exp_f32 v38, v38
  v_exp_f32 v39, v39
  v_mfma_f32_32x32x8_bf16 v[64:79], v[228:229], v[204:205], 0
  v_exp_f32 v40, v40
  v_exp_f32 v41, v41
  v_exp_f32 v42, v42
  v_exp_f32 v43, v43
  v_mfma_f32_32x32x16_bf16 v[64:79], v[224:227], v[200:203], v[64:79]
  v_exp_f32 v44, v44
  v_exp_f32 v45, v45
  v_exp_f32 v46, v46
  v_exp_f32 v47, v47
  s_setprio 1
  s_waitcnt lgkmcnt(0)
  ds_read_b128 v[224:227], v2 offset:0
  ds_read_b64 v[228:229], v3 offset:0
  ds_read_b64_tr_b16 v[244:245], v4 offset:3072
  ds_read_b64_tr_b16 v[246:247], v4 offset:3264
  ds_read_b64_tr_b16 v[248:249], v4 offset:3840
  ds_read_b64_tr_b16 v[250:251], v4 offset:4032
  v_smfmac_f32_32x32x32_bf16 v[136:151], v[236:239], v[32:39], v18
  v_exp_f32 v48, v48
  v_exp_f32 v49, v49
  v_exp_f32 v50, v50
  v_exp_f32 v51, v51
  v_smfmac_f32_32x32x32_bf16 v[136:151], v[240:243], v[40:47], v18
  v_exp_f32 v52, v52
  v_exp_f32 v53, v53
  v_exp_f32 v54, v54
  v_exp_f32 v55, v55
  v_mfma_f32_32x32x8_bf16 v[80:95], v[234:235], v[204:205], 0
  v_exp_f32 v56, v56
  v_exp_f32 v57, v57
  v_exp_f32 v58, v58
  v_exp_f32 v59, v59
  v_mfma_f32_32x32x16_bf16 v[80:95], v[230:233], v[200:203], v[80:95]
  v_exp_f32 v60, v60
  v_exp_f32 v61, v61
  v_exp_f32 v62, v62
  v_exp_f32 v63, v63
  s_setprio 0
  s_waitcnt lgkmcnt(0)
  s_barrier
  ds_read_b128 v[212:215], v20 offset:1024
  ds_read_b64 v[216:217], v22 offset:512
  ds_read_b128 v[218:221], v21 offset:1024
  ds_read_b64 v[222:223], v23 offset:512
  ds_read_b64_tr_b16 v[236:237], v4 offset:6144
  ds_read_b64_tr_b16 v[238:239], v4 offset:6336
  ds_read_b64_tr_b16 v[240:241], v4 offset:6912
  ds_read_b64_tr_b16 v[242:243], v4 offset:7104
  v_smfmac_f32_32x32x32_bf16 v[136:151], v[244:247], v[48:55], v18
  v_exp_f32 v64, v64
  v_exp_f32 v65, v65
  v_exp_f32 v66, v66
  v_exp_f32 v67, v67
  v_smfmac_f32_32x32x32_bf16 v[136:151], v[248:251], v[56:63], v18
  v_exp_f32 v68, v68
  v_exp_f32 v69, v69
  v_exp_f32 v70, v70
  v_exp_f32 v71, v71
  s_waitcnt lgkmcnt(0)
  v_mfma_f32_32x32x8_bf16 v[32:47], v[228:229], v[216:217], 0
  v_exp_f32 v72, v72
  v_exp_f32 v73, v73
  v_exp_f32 v74, v74
  v_exp_f32 v75, v75
  v_mfma_f32_32x32x16_bf16 v[32:47], v[224:227], v[212:215], v[32:47]
  v_exp_f32 v76, v76
  v_exp_f32 v77, v77
  v_exp_f32 v78, v78
  v_exp_f32 v79, v79
  s_setprio 3
  s_waitcnt lgkmcnt(0)
  ds_read_b128 v[230:233], v2 offset:1024
  ds_read_b64 v[234:235], v3 offset:512
  ds_read_b64_tr_b16 v[244:245], v4 offset:9216
  ds_read_b64_tr_b16 v[246:247], v4 offset:9408
  ds_read_b64_tr_b16 v[248:249], v4 offset:9984
  ds_read_b64_tr_b16 v[250:251], v4 offset:10176
  v_smfmac_f32_32x32x32_bf16 v[136:151], v[236:239], v[64:71], v18
  v_exp_f32 v80, v80
  v_exp_f32 v81, v81
  v_exp_f32 v82, v82
  v_exp_f32 v83, v83
  v_smfmac_f32_32x32x32_bf16 v[136:151], v[240:243], v[72:79], v18
  v_exp_f32 v84, v84
  v_exp_f32 v85, v85
  v_exp_f32 v86, v86
  v_exp_f32 v87, v87
  v_mfma_f32_32x32x8_bf16 v[48:63], v[228:229], v[222:223], 0
  v_exp_f32 v88, v88
  v_exp_f32 v89, v89
  v_exp_f32 v90, v90
  v_exp_f32 v91, v91
  v_mfma_f32_32x32x16_bf16 v[48:63], v[224:227], v[218:221], v[48:63]
  v_exp_f32 v92, v92
  v_exp_f32 v93, v93
  v_exp_f32 v94, v94
  v_exp_f32 v95, v95
  s_waitcnt lgkmcnt(0)
  ds_read_b64_tr_b16 v[236:237], v4 offset:0
  ds_read_b64_tr_b16 v[238:239], v4 offset:192
  ds_read_b64_tr_b16 v[240:241], v4 offset:768
  ds_read_b64_tr_b16 v[242:243], v4 offset:960
  v_smfmac_f32_32x32x32_bf16 v[136:151], v[244:247], v[80:87], v18
  v_exp_f32 v32, v32
  v_exp_f32 v33, v33
  v_exp_f32 v34, v34
  v_exp_f32 v35, v35
  v_smfmac_f32_32x32x32_bf16 v[136:151], v[248:251], v[88:95], v18
  v_exp_f32 v36, v36
  v_exp_f32 v37, v37
  v_exp_f32 v38, v38
  v_exp_f32 v39, v39
  v_mfma_f32_32x32x8_bf16 v[64:79], v[234:235], v[216:217], 0
  v_exp_f32 v40, v40
  v_exp_f32 v41, v41
  v_exp_f32 v42, v42
  v_exp_f32 v43, v43
  v_mfma_f32_32x32x16_bf16 v[64:79], v[230:233], v[212:215], v[64:79]
  v_exp_f32 v44, v44
  v_exp_f32 v45, v45
  v_exp_f32 v46, v46
  v_exp_f32 v47, v47
  s_setprio 2
  s_waitcnt lgkmcnt(0)
  v_add_u32 v11, 24576, v9
  v_add_u32 v12, 24576, v10
  s_waitcnt vmcnt(0)
  v_dot2_f32_bf16 v14, v96, v96, 0
  v_dot2_f32_bf16 v15, v97, v97, 0
  v_dot2_f32_bf16 v14, v98, v98, v14
  v_dot2_f32_bf16 v15, v99, v99, v15
  v_dot2_f32_bf16 v14, v100, v100, v14
  v_dot2_f32_bf16 v15, v101, v101, v15
  v_dot2_f32_bf16 v14, v102, v102, v14
  v_dot2_f32_bf16 v15, v103, v103, v15
  v_dot2_f32_bf16 v14, v104, v104, v14
  v_dot2_f32_bf16 v15, v105, v105, v15
  v_lshlrev_b32 v106, 16, v96
  v_and_b32 v107, 0xffff0000, v96
  v_lshlrev_b32 v108, 16, v97
  v_and_b32 v109, 0xffff0000, v97
  v_add_f32 v14, v14, v15
  v_sqrt_f32 v14, v14
  v_lshlrev_b32 v110, 16, v98
  v_and_b32 v111, 0xffff0000, v98
  v_lshlrev_b32 v112, 16, v99
  v_and_b32 v113, 0xffff0000, v99
  v_lshlrev_b32 v114, 16, v100
  v_and_b32 v115, 0xffff0000, v100
  v_add_f32 v14, 0x358637bd, v14
  v_rcp_f32 v16, v14
  v_lshlrev_b32 v116, 16, v101
  v_and_b32 v117, 0xffff0000, v101
  v_lshlrev_b32 v118, 16, v102
  v_and_b32 v119, 0xffff0000, v102
  v_lshlrev_b32 v120, 16, v103
  v_and_b32 v121, 0xffff0000, v103
  v_lshlrev_b32 v122, 16, v104
  v_and_b32 v123, 0xffff0000, v104
  v_lshlrev_b32 v124, 16, v105
  v_and_b32 v125, 0xffff0000, v105
  v_pk_mul_f32 v[106:107], v[106:107], v[16:17] op_sel_hi:[1,0]
  v_pk_mul_f32 v[108:109], v[108:109], v[16:17] op_sel_hi:[1,0]
  v_pk_mul_f32 v[110:111], v[110:111], v[16:17] op_sel_hi:[1,0]
  v_pk_mul_f32 v[112:113], v[112:113], v[16:17] op_sel_hi:[1,0]
  v_pk_mul_f32 v[114:115], v[114:115], v[16:17] op_sel_hi:[1,0]
  v_pk_mul_f32 v[116:117], v[116:117], v[16:17] op_sel_hi:[1,0]
  v_pk_mul_f32 v[118:119], v[118:119], v[16:17] op_sel_hi:[1,0]
  v_pk_mul_f32 v[120:121], v[120:121], v[16:17] op_sel_hi:[1,0]
  v_pk_mul_f32 v[122:123], v[122:123], v[16:17] op_sel_hi:[1,0]
  v_pk_mul_f32 v[124:125], v[124:125], v[16:17] op_sel_hi:[1,0]
  v_cvt_pk_bf16_f32 v96, v106, v107
  v_cvt_pk_bf16_f32 v97, v108, v109
  v_cvt_pk_bf16_f32 v98, v110, v111
  v_cvt_pk_bf16_f32 v99, v112, v113
  v_cvt_pk_bf16_f32 v100, v114, v115
  v_cvt_pk_bf16_f32 v101, v116, v117
  v_cvt_pk_bf16_f32 v102, v118, v119
  v_cvt_pk_bf16_f32 v103, v120, v121
  v_cvt_pk_bf16_f32 v104, v122, v123
  v_cvt_pk_bf16_f32 v105, v124, v125
  ds_write_b128 v11, v[96:99] offset:0
  ds_write_b128 v11, v[100:103] offset:4096
  ds_write_b64 v12, v[104:105] offset:8192
  s_mov_b32 s43, 20480
  buffer_load_dwordx4 v[96:99], v8, s[36:39], s43 offen
  buffer_load_dwordx4 v[100:103], v8, s[36:39], s43 offen offset:16
  buffer_load_dwordx2 v[104:105], v8, s[36:39], s43 offen offset:32
  ds_read_b128 v[224:227], v2 offset:2048
  ds_read_b64 v[228:229], v3 offset:1024
  v_smfmac_f32_32x32x32_bf16 v[168:183], v[236:239], v[32:39], v18
  v_exp_f32 v48, v48
  v_exp_f32 v49, v49
  v_exp_f32 v50, v50
  v_exp_f32 v51, v51
  v_smfmac_f32_32x32x32_bf16 v[168:183], v[240:243], v[40:47], v18
  v_exp_f32 v52, v52
  v_exp_f32 v53, v53
  v_exp_f32 v54, v54
  v_exp_f32 v55, v55
  v_mfma_f32_32x32x8_bf16 v[80:95], v[234:235], v[222:223], 0
  v_exp_f32 v56, v56
  v_exp_f32 v57, v57
  v_exp_f32 v58, v58
  v_exp_f32 v59, v59
  v_mfma_f32_32x32x16_bf16 v[80:95], v[230:233], v[218:221], v[80:95]
  v_exp_f32 v60, v60
  v_exp_f32 v61, v61
  v_exp_f32 v62, v62
  v_exp_f32 v63, v63
  s_waitcnt lgkmcnt(0)
  ds_read_b64_tr_b16 v[244:245], v4 offset:3072
  ds_read_b64_tr_b16 v[246:247], v4 offset:3264
  ds_read_b64_tr_b16 v[248:249], v4 offset:3840
  ds_read_b64_tr_b16 v[250:251], v4 offset:4032
  v_smfmac_f32_32x32x32_bf16 v[184:199], v[236:239], v[48:55], v18
  v_exp_f32 v64, v64
  v_exp_f32 v65, v65
  v_exp_f32 v66, v66
  v_exp_f32 v67, v67
  v_smfmac_f32_32x32x32_bf16 v[184:199], v[240:243], v[56:63], v18
  v_exp_f32 v68, v68
  v_exp_f32 v69, v69
  v_exp_f32 v70, v70
  v_exp_f32 v71, v71
  v_mfma_f32_32x32x8_bf16 v[32:47], v[228:229], v[216:217], 0
  v_exp_f32 v72, v72
  v_exp_f32 v73, v73
  v_exp_f32 v74, v74
  v_exp_f32 v75, v75
  v_mfma_f32_32x32x16_bf16 v[32:47], v[224:227], v[212:215], v[32:47]
  v_exp_f32 v76, v76
  v_exp_f32 v77, v77
  v_exp_f32 v78, v78
  v_exp_f32 v79, v79
  s_setprio 1
  s_waitcnt lgkmcnt(0)
  ds_read_b128 v[230:233], v2 offset:3072
  ds_read_b64 v[234:235], v3 offset:1536
  v_smfmac_f32_32x32x32_bf16 v[168:183], v[244:247], v[64:71], v18
  v_exp_f32 v80, v80
  v_exp_f32 v81, v81
  v_exp_f32 v82, v82
  v_exp_f32 v83, v83
  v_smfmac_f32_32x32x32_bf16 v[168:183], v[248:251], v[72:79], v18
  v_exp_f32 v84, v84
  v_exp_f32 v85, v85
  v_exp_f32 v86, v86
  v_exp_f32 v87, v87
  v_mfma_f32_32x32x8_bf16 v[48:63], v[228:229], v[222:223], 0
  v_exp_f32 v88, v88
  v_exp_f32 v89, v89
  v_exp_f32 v90, v90
  v_exp_f32 v91, v91
  v_mfma_f32_32x32x16_bf16 v[48:63], v[224:227], v[218:221], v[48:63]
  v_exp_f32 v92, v92
  v_exp_f32 v93, v93
  v_exp_f32 v94, v94
  v_exp_f32 v95, v95
  s_waitcnt lgkmcnt(0)
  ds_read_b64_tr_b16 v[236:237], v4 offset:6144
  ds_read_b64_tr_b16 v[238:239], v4 offset:6336
  ds_read_b64_tr_b16 v[240:241], v4 offset:6912
  ds_read_b64_tr_b16 v[242:243], v4 offset:7104
  v_smfmac_f32_32x32x32_bf16 v[184:199], v[244:247], v[80:87], v18
  v_exp_f32 v32, v32
  v_exp_f32 v33, v33
  v_exp_f32 v34, v34
  v_exp_f32 v35, v35
  v_smfmac_f32_32x32x32_bf16 v[184:199], v[248:251], v[88:95], v18
  v_exp_f32 v36, v36
  v_exp_f32 v37, v37
  v_exp_f32 v38, v38
  v_exp_f32 v39, v39
  v_mfma_f32_32x32x8_bf16 v[64:79], v[234:235], v[216:217], 0
  v_exp_f32 v40, v40
  v_exp_f32 v41, v41
  v_exp_f32 v42, v42
  v_exp_f32 v43, v43
  v_mfma_f32_32x32x16_bf16 v[64:79], v[230:233], v[212:215], v[64:79]
  v_exp_f32 v44, v44
  v_exp_f32 v45, v45
  v_exp_f32 v46, v46
  v_exp_f32 v47, v47
  s_setprio 0
  s_waitcnt lgkmcnt(0)
  v_smfmac_f32_32x32x32_bf16 v[168:183], v[236:239], v[32:39], v18
  v_exp_f32 v48, v48
  v_exp_f32 v49, v49
  v_exp_f32 v50, v50
  v_exp_f32 v51, v51
  v_smfmac_f32_32x32x32_bf16 v[168:183], v[240:243], v[40:47], v18
  v_exp_f32 v52, v52
  v_exp_f32 v53, v53
  v_exp_f32 v54, v54
  v_exp_f32 v55, v55
  s_waitcnt lgkmcnt(0)
  s_barrier
  v_add_u32 v2, 24576, v5
  v_add_u32 v3, 24576, v6
  ds_read_b128 v[224:227], v2 offset:0
  ds_read_b64 v[228:229], v3 offset:0
  v_mfma_f32_32x32x8_bf16 v[80:95], v[234:235], v[222:223], 0
  v_exp_f32 v56, v56
  v_exp_f32 v57, v57
  v_exp_f32 v58, v58
  v_exp_f32 v59, v59
  v_mfma_f32_32x32x16_bf16 v[80:95], v[230:233], v[218:221], v[80:95]
  v_exp_f32 v60, v60
  v_exp_f32 v61, v61
  v_exp_f32 v62, v62
  v_exp_f32 v63, v63
  s_setprio 3
  s_waitcnt lgkmcnt(0)
  ds_read_b64_tr_b16 v[244:245], v4 offset:9216
  ds_read_b64_tr_b16 v[246:247], v4 offset:9408
  ds_read_b64_tr_b16 v[248:249], v4 offset:9984
  ds_read_b64_tr_b16 v[250:251], v4 offset:10176
  v_smfmac_f32_32x32x32_bf16 v[184:199], v[236:239], v[48:55], v18
  v_exp_f32 v64, v64
  v_exp_f32 v65, v65
  v_exp_f32 v66, v66
  v_exp_f32 v67, v67
  v_smfmac_f32_32x32x32_bf16 v[184:199], v[240:243], v[56:63], v18
  v_exp_f32 v68, v68
  v_exp_f32 v69, v69
  v_exp_f32 v70, v70
  v_exp_f32 v71, v71
  v_mfma_f32_32x32x8_bf16 v[32:47], v[228:229], v[204:205], 0
  v_exp_f32 v72, v72
  v_exp_f32 v73, v73
  v_exp_f32 v74, v74
  v_exp_f32 v75, v75
  v_mfma_f32_32x32x16_bf16 v[32:47], v[224:227], v[200:203], v[32:47]
  v_exp_f32 v76, v76
  v_exp_f32 v77, v77
  v_exp_f32 v78, v78
  v_exp_f32 v79, v79
  s_waitcnt lgkmcnt(0)
  v_add_u32 v4, 24576, v7
  ds_read_b64_tr_b16 v[236:237], v4 offset:0
  ds_read_b64_tr_b16 v[238:239], v4 offset:192
  ds_read_b64_tr_b16 v[240:241], v4 offset:768
  ds_read_b64_tr_b16 v[242:243], v4 offset:960
  v_smfmac_f32_32x32x32_bf16 v[168:183], v[244:247], v[64:71], v18
  v_exp_f32 v80, v80
  v_exp_f32 v81, v81
  v_exp_f32 v82, v82
  v_exp_f32 v83, v83
  v_smfmac_f32_32x32x32_bf16 v[168:183], v[248:251], v[72:79], v18
  v_exp_f32 v84, v84
  v_exp_f32 v85, v85
  v_exp_f32 v86, v86
  v_exp_f32 v87, v87
  v_mfma_f32_32x32x8_bf16 v[48:63], v[228:229], v[210:211], 0
  v_exp_f32 v88, v88
  v_exp_f32 v89, v89
  v_exp_f32 v90, v90
  v_exp_f32 v91, v91
  v_mfma_f32_32x32x16_bf16 v[48:63], v[224:227], v[206:209], v[48:63]
  v_exp_f32 v92, v92
  v_exp_f32 v93, v93
  v_exp_f32 v94, v94
  v_exp_f32 v95, v95
  s_mov_b32 s42, 0
  s_mov_b32 s44, 6
  s_branch L_loop
L_proV:
  s_waitcnt vmcnt(0)
  v_dot2_f32_bf16 v14, v32, v32, 0
  v_dot2_f32_bf16 v15, v33, v33, 0
  v_dot2_f32_bf16 v14, v34, v34, v14
  v_dot2_f32_bf16 v15, v35, v35, v15
  v_dot2_f32_bf16 v14, v36, v36, v14
  v_dot2_f32_bf16 v15, v37, v37, v15
  v_lshlrev_b32 v48, 16, v32
  v_and_b32 v49, 0xffff0000, v32
  v_lshlrev_b32 v50, 16, v33
  v_and_b32 v51, 0xffff0000, v33
  v_add_f32 v16, v14, v15
  v_add_f32 v15, v14, v15
  v_lshlrev_b32 v52, 16, v34
  v_and_b32 v53, 0xffff0000, v34
  v_permlane32_swap_b32 v16, v15
  v_lshlrev_b32 v54, 16, v35
  v_and_b32 v55, 0xffff0000, v35
  v_add_f32 v14, v16, v15
  v_sqrt_f32 v14, v14
  v_lshlrev_b32 v56, 16, v36
  v_and_b32 v57, 0xffff0000, v36
  v_add_f32 v14, 0x358637bd, v14
  v_rcp_f32 v16, v14
  v_lshlrev_b32 v58, 16, v37
  v_and_b32 v59, 0xffff0000, v37
  v_mul_f32 v16, v16, v17
  s_nop 0
  v_pk_mul_f32 v[48:49], v[48:49], v[16:17] op_sel_hi:[1,0]
  v_pk_mul_f32 v[50:51], v[50:51], v[16:17] op_sel_hi:[1,0]
  v_pk_mul_f32 v[52:53], v[52:53], v[16:17] op_sel_hi:[1,0]
  v_pk_mul_f32 v[54:55], v[54:55], v[16:17] op_sel_hi:[1,0]
  v_pk_mul_f32 v[56:57], v[56:57], v[16:17] op_sel_hi:[1,0]
  v_pk_mul_f32 v[58:59], v[58:59], v[16:17] op_sel_hi:[1,0]
  v_cvt_pk_bf16_f32 v32, v48, v49
  v_cvt_pk_bf16_f32 v33, v50, v51
  v_cvt_pk_bf16_f32 v34, v52, v53
  v_cvt_pk_bf16_f32 v35, v54, v55
  v_cvt_pk_bf16_f32 v36, v56, v57
  v_cvt_pk_bf16_f32 v37, v58, v59
  ds_write_b128 v20, v[32:35]
  s_mov_b32 exec_hi, 0
  ds_write_b64 v22, v[36:37]
  s_mov_b32 exec_hi, -1
  s_and_b32 s3, s34, 0x7fffffff
  s_waitcnt lgkmcnt(0)
  s_barrier
  s_cmp_gt_u32 s3, 0x41800000
  s_cbranch_scc1 L_fallback
L_go1:
  ds_read_b128 v[224:227], v2 offset:0
  ds_read_b64 v[228:229], v3 offset:0
  ds_read_b128 v[200:203], v20 offset:0
  ds_read_b64 v[204:205], v22 offset:0
  ds_read_b128 v[230:233], v2 offset:1024
  ds_read_b64 v[234:235], v3 offset:512
  ds_read_b64_tr_b16 v[236:237], v4 offset:0
  ds_read_b64_tr_b16 v[238:239], v4 offset:192
  ds_read_b64_tr_b16 v[240:241], v4 offset:768
  ds_read_b64_tr_b16 v[242:243], v4 offset:960
  s_waitcnt lgkmcnt(6)
  v_mfma_f32_32x32x8_bf16 v[32:47], v[228:229], v[204:205], 0
  v_mfma_f32_32x32x16_bf16 v[32:47], v[224:227], v[200:203], v[32:47]
  s_waitcnt lgkmcnt(4)
  v_mfma_f32_32x32x8_bf16 v[48:63], v[234:235], v[204:205], 0
  v_mfma_f32_32x32x16_bf16 v[48:63], v[230:233], v[200:203], v[48:63]
  ds_read_b128 v[224:227], v2 offset:2048
  ds_read_b64 v[228:229], v3 offset:1024
  s_nop 7
  s_setprio 3
  s_waitcnt lgkmcnt(0)
  ds_read_b128 v[230:233], v2 offset:3072
  ds_read_b64 v[234:235], v3 offset:1536
  v_exp_f32 v32, v32
  v_exp_f32 v33, v33
  buffer_load_dwordx4 v[126:129], v13, s[4:7], 0 offen offset:2560
  buffer_load_dwordx4 v[130:133], v13, s[4:7], 0 offen offset:2576
  buffer_load_dwordx2 v[134:135], v13, s[4:7], 0 offen offset:2592
  v_exp_f32 v34, v34
  v_exp_f32 v35, v35
  v_exp_f32 v36, v36
  v_exp_f32 v37, v37
  v_exp_f32 v38, v38
  v_exp_f32 v39, v39
  v_mfma_f32_32x32x8_bf16 v[64:79], v[228:229], v[204:205], 0
  v_exp_f32 v40, v40
  v_exp_f32 v41, v41
  v_exp_f32 v42, v42
  v_exp_f32 v43, v43
  v_mfma_f32_32x32x16_bf16 v[64:79], v[224:227], v[200:203], v[64:79]
  v_exp_f32 v44, v44
  v_exp_f32 v45, v45
  v_exp_f32 v46, v46
  v_exp_f32 v47, v47
  s_setprio 2
  s_waitcnt lgkmcnt(0)
  ds_read_b128 v[224:227], v2 offset:0
  ds_read_b64 v[228:229], v3 offset:0
  ds_read_b64_tr_b16 v[244:245], v4 offset:3072
  ds_read_b64_tr_b16 v[246:247], v4 offset:3264
  ds_read_b64_tr_b16 v[248:249], v4 offset:3840
  ds_read_b64_tr_b16 v[250:251], v4 offset:4032
  v_smfmac_f32_32x32x32_bf16 v[136:151], v[236:239], v[32:39], v18
  v_exp_f32 v48, v48
  v_exp_f32 v49, v49
  v_exp_f32 v50, v50
  v_exp_f32 v51, v51
  v_smfmac_f32_32x32x32_bf16 v[136:151], v[240:243], v[40:47], v18
  v_exp_f32 v52, v52
  v_exp_f32 v53, v53
  v_exp_f32 v54, v54
  v_exp_f32 v55, v55
  v_mfma_f32_32x32x8_bf16 v[80:95], v[234:235], v[204:205], 0
  v_exp_f32 v56, v56
  v_exp_f32 v57, v57
  v_exp_f32 v58, v58
  v_exp_f32 v59, v59
  v_mfma_f32_32x32x16_bf16 v[80:95], v[230:233], v[200:203], v[80:95]
  v_exp_f32 v60, v60
  v_exp_f32 v61, v61
  v_exp_f32 v62, v62
  v_exp_f32 v63, v63
  s_setprio 3
  s_waitcnt lgkmcnt(0)
  s_barrier
  ds_read_b128 v[206:209], v21 offset:0
  ds_read_b64 v[210:211], v23 offset:0
  ds_read_b128 v[230:233], v2 offset:1024
  ds_read_b64 v[234:235], v3 offset:512
  ds_read_b64_tr_b16 v[236:237], v4 offset:6144
  ds_read_b64_tr_b16 v[238:239], v4 offset:6336
  ds_read_b64_tr_b16 v[240:241], v4 offset:6912
  ds_read_b64_tr_b16 v[242:243], v4 offset:7104
  v_smfmac_f32_32x32x32_bf16 v[136:151], v[244:247], v[48:55], v18
  v_exp_f32 v64, v64
  v_exp_f32 v65, v65
  v_exp_f32 v66, v66
  v_exp_f32 v67, v67
  s_mov_b32 s43, 10240
  buffer_load_dwordx4 v[96:99], v8, s[36:39], s43 offen
  buffer_load_dwordx4 v[100:103], v8, s[36:39], s43 offen offset:16
  buffer_load_dwordx2 v[104:105], v8, s[36:39], s43 offen offset:32
  v_smfmac_f32_32x32x32_bf16 v[136:151], v[248:251], v[56:63], v18
  v_exp_f32 v68, v68
  v_exp_f32 v69, v69
  v_exp_f32 v70, v70
  v_exp_f32 v71, v71
  s_waitcnt lgkmcnt(0)
  v_mfma_f32_32x32x8_bf16 v[32:47], v[228:229], v[210:211], 0
  v_exp_f32 v72, v72
  v_exp_f32 v73, v73
  v_exp_f32 v74, v74
  v_exp_f32 v75, v75
  v_mfma_f32_32x32x16_bf16 v[32:47], v[224:227], v[206:209], v[32:47]
  v_exp_f32 v76, v76
  v_exp_f32 v77, v77
  v_exp_f32 v78, v78
  v_exp_f32 v79, v79
  s_setprio 3
  s_waitcnt lgkmcnt(0)
  ds_read_b128 v[224:227], v2 offset:2048
  ds_read_b64 v[228:229], v3 offset:1024
  ds_read_b64_tr_b16 v[244:245], v4 offset:9216
  ds_read_b64_tr_b16 v[246:247], v4 offset:9408
  ds_read_b64_tr_b16 v[248:249], v4 offset:9984
  ds_read_b64_tr_b16 v[250:251], v4 offset:10176
  v_smfmac_f32_32x32x32_bf16 v[136:151], v[236:239], v[64:71], v18
  v_exp_f32 v80, v80
  v_exp_f32 v81, v81
  v_exp_f32 v82, v82
  v_exp_f32 v83, v83
  v_smfmac_f32_32x32x32_bf16 v[136:151], v[240:243], v[72:79], v18
  v_exp_f32 v84, v84
  v_exp_f32 v85, v85
  v_exp_f32 v86, v86
  v_exp_f32 v87, v87
  v_mfma_f32_32x32x8_bf16 v[48:63], v[234:235], v[210:211], 0
  v_exp_f32 v88, v88
  v_exp_f32 v89, v89
  v_exp_f32 v90, v90
  v_exp_f32 v91, v91
  v_mfma_f32_32x32x16_bf16 v[48:63], v[230:233], v[206:209], v[48:63]
  v_exp_f32 v92, v92
  v_exp_f32 v93, v93
  v_exp_f32 v94, v94
  v_exp_f32 v95, v95
  s_setprio 3
  s_waitcnt lgkmcnt(0)
  ds_read_b128 v[230:233], v2 offset:3072
  ds_read_b64 v[234:235], v3 offset:1536
  ds_read_b64_tr_b16 v[236:237], v4 offset:0
  ds_read_b64_tr_b16 v[238:239], v4 offset:192
  ds_read_b64_tr_b16 v[240:241], v4 offset:768
  ds_read_b64_tr_b16 v[242:243], v4 offset:960
  v_smfmac_f32_32x32x32_bf16 v[136:151], v[244:247], v[80:87], v18
  v_exp_f32 v32, v32
  v_exp_f32 v33, v33
  v_exp_f32 v34, v34
  v_exp_f32 v35, v35
  v_smfmac_f32_32x32x32_bf16 v[136:151], v[248:251], v[88:95], v18
  v_exp_f32 v36, v36
  v_exp_f32 v37, v37
  v_exp_f32 v38, v38
  v_exp_f32 v39, v39
  v_mfma_f32_32x32x8_bf16 v[64:79], v[228:229], v[210:211], 0
  v_exp_f32 v40, v40
  v_exp_f32 v41, v41
  v_exp_f32 v42, v42
  v_exp_f32 v43, v43
  v_mfma_f32_32x32x16_bf16 v[64:79], v[224:227], v[206:209], v[64:79]
  v_exp_f32 v44, v44
  v_exp_f32 v45, v45
  v_exp_f32 v46, v46
  v_exp_f32 v47, v47
  s_setprio 1
  s_waitcnt lgkmcnt(0)
  s_waitcnt vmcnt(3)
  v_and_b32 v12, 0xc0, v0
  v_lshl_add_u32 v12, v12, 1, v1
  v_lshlrev_b32 v11, 4, v12
  v_lshl_add_u32 v12, v12, 3, s52
  v_dot2_f32_bf16 v14, v126, v126, 0
  v_dot2_f32_bf16 v15, v127, v127, 0
  v_dot2_f32_bf16 v14, v128, v128, v14
  v_dot2_f32_bf16 v15, v129, v129, v15
  v_dot2_f32_bf16 v14, v130, v130, v14
  v_dot2_f32_bf16 v15, v131, v131, v15
  v_dot2_f32_bf16 v14, v132, v132, v14
  v_dot2_f32_bf16 v15, v133, v133, v15
  v_dot2_f32_bf16 v14, v134, v134, v14
  v_dot2_f32_bf16 v15, v135, v135, v15
  v_lshlrev_b32 v106, 16, v126
  v_and_b32 v107, 0xffff0000, v126
  v_lshlrev_b32 v108, 16, v127
  v_and_b32 v109, 0xffff0000, v127
  v_add_f32 v14, v14, v15
  v_sqrt_f32 v14, v14
  v_lshlrev_b32 v110, 16, v128
  v_and_b32 v111, 0xffff0000, v128
  v_lshlrev_b32 v112, 16, v129
  v_and_b32 v113, 0xffff0000, v129
  v_lshlrev_b32 v114, 16, v130
  v_and_b32 v115, 0xffff0000, v130
  v_add_f32 v14, 0x358637bd, v14
  v_rcp_f32 v16, v14
  v_lshlrev_b32 v116, 16, v131
  v_and_b32 v117, 0xffff0000, v131
  v_lshlrev_b32 v118, 16, v132
  v_and_b32 v119, 0xffff0000, v132
  v_lshlrev_b32 v120, 16, v133
  v_and_b32 v121, 0xffff0000, v133
  v_lshlrev_b32 v122, 16, v134
  v_and_b32 v123, 0xffff0000, v134
  v_lshlrev_b32 v124, 16, v135
  v_and_b32 v125, 0xffff0000, v135
  v_mul_f32 v16, v16, v17
  s_nop 0
  v_pk_mul_f32 v[106:107], v[106:107], v[16:17] op_sel_hi:[1,0]
  v_pk_mul_f32 v[108:109], v[108:109], v[16:17] op_sel_hi:[1,0]
  v_pk_mul_f32 v[110:111], v[110:111], v[16:17] op_sel_hi:[1,0]
  v_pk_mul_f32 v[112:113], v[112:113], v[16:17] op_sel_hi:[1,0]
  v_pk_mul_f32 v[114:115], v[114:115], v[16:17] op_sel_hi:[1,0]
  v_pk_mul_f32 v[116:117], v[116:117], v[16:17] op_sel_hi:[1,0]
  v_pk_mul_f32 v[118:119], v[118:119], v[16:17] op_sel_hi:[1,0]
  v_pk_mul_f32 v[120:121], v[120:121], v[16:17] op_sel_hi:[1,0]
  v_pk_mul_f32 v[122:123], v[122:123], v[16:17] op_sel_hi:[1,0]
  v_pk_mul_f32 v[124:125], v[124:125], v[16:17] op_sel_hi:[1,0]
  v_cvt_pk_bf16_f32 v126, v106, v107
  v_cvt_pk_bf16_f32 v127, v108, v109
  v_cvt_pk_bf16_f32 v128, v110, v111
  v_cvt_pk_bf16_f32 v129, v112, v113
  v_cvt_pk_bf16_f32 v130, v114, v115
  v_cvt_pk_bf16_f32 v131, v116, v117
  v_cvt_pk_bf16_f32 v132, v118, v119
  v_cvt_pk_bf16_f32 v133, v120, v121
  v_cvt_pk_bf16_f32 v134, v122, v123
  v_cvt_pk_bf16_f32 v135, v124, v125
  ds_write_b128 v11, v[126:129] offset:50176
  ds_write_b128 v11, v[130:133] offset:58368
  ds_write_b64 v12, v[134:135] offset:512
  ds_read_b128 v[224:227], v2 offset:0
  ds_read_b64 v[228:229], v3 offset:0
  ds_read_b64_tr_b16 v[244:245], v4 offset:3072
  ds_read_b64_tr_b16 v[246:247], v4 offset:3264
  ds_read_b64_tr_b16 v[248:249], v4 offset:3840
  ds_read_b64_tr_b16 v[250:251], v4 offset:4032
  v_smfmac_f32_32x32x32_bf16 v[152:167], v[236:239], v[32:39], v18
  v_exp_f32 v48, v48
  v_exp_f32 v49, v49
  v_exp_f32 v50, v50
  v_exp_f32 v51, v51
  v_smfmac_f32_32x32x32_bf16 v[152:167], v[240:243], v[40:47], v18
  v_exp_f32 v52, v52
  v_exp_f32 v53, v53
  v_exp_f32 v54, v54
  v_exp_f32 v55, v55
  v_mfma_f32_32x32x8_bf16 v[80:95], v[234:235], v[210:211], 0
  v_exp_f32 v56, v56
  v_exp_f32 v57, v57
  v_exp_f32 v58, v58
  v_exp_f32 v59, v59
  v_mfma_f32_32x32x16_bf16 v[80:95], v[230:233], v[206:209], v[80:95]
  v_exp_f32 v60, v60
  v_exp_f32 v61, v61
  v_exp_f32 v62, v62
  v_exp_f32 v63, v63
  s_setprio 0
  s_waitcnt lgkmcnt(0)
  s_barrier
  ds_read_b128 v[212:215], v20 offset:1024
  ds_read_b64 v[216:217], v22 offset:512
  ds_read_b128 v[218:221], v21 offset:1024
  ds_read_b64 v[222:223], v23 offset:512
  ds_read_b64_tr_b16 v[236:237], v4 offset:6144
  ds_read_b64_tr_b16 v[238:239], v4 offset:6336
  ds_read_b64_tr_b16 v[240:241], v4 offset:6912
  ds_read_b64_tr_b16 v[242:243], v4 offset:7104
  v_smfmac_f32_32x32x32_bf16 v[152:167], v[244:247], v[48:55], v18
  v_exp_f32 v64, v64
  v_exp_f32 v65, v65
  v_exp_f32 v66, v66
  v_exp_f32 v67, v67
  v_smfmac_f32_32x32x32_bf16 v[152:167], v[248:251], v[56:63], v18
  v_exp_f32 v68, v68
  v_exp_f32 v69, v69
  v_exp_f32 v70, v70
  v_exp_f32 v71, v71
  s_waitcnt lgkmcnt(0)
  v_mfma_f32_32x32x8_bf16 v[32:47], v[228:229], v[216:217], 0
  v_exp_f32 v72, v72
  v_exp_f32 v73, v73
  v_exp_f32 v74, v74
  v_exp_f32 v75, v75
  v_mfma_f32_32x32x16_bf16 v[32:47], v[224:227], v[212:215], v[32:47]
  v_exp_f32 v76, v76
  v_exp_f32 v77, v77
  v_exp_f32 v78, v78
  v_exp_f32 v79, v79
  s_setprio 3
  s_waitcnt lgkmcnt(0)
  ds_read_b128 v[230:233], v2 offset:1024
  ds_read_b64 v[234:235], v3 offset:512
  ds_read_b64_tr_b16 v[244:245], v4 offset:9216
  ds_read_b64_tr_b16 v[246:247], v4 offset:9408
  ds_read_b64_tr_b16 v[248:249], v4 offset:9984
  ds_read_b64_tr_b16 v[250:251], v4 offset:10176
  v_smfmac_f32_32x32x32_bf16 v[152:167], v[236:239], v[64:71], v18
  v_exp_f32 v80, v80
  v_exp_f32 v81, v81
  v_exp_f32 v82, v82
  v_exp_f32 v83, v83
  v_smfmac_f32_32x32x32_bf16 v[152:167], v[240:243], v[72:79], v18
  v_exp_f32 v84, v84
  v_exp_f32 v85, v85
  v_exp_f32 v86, v86
  v_exp_f32 v87, v87
  v_mfma_f32_32x32x8_bf16 v[48:63], v[228:229], v[222:223], 0
  v_exp_f32 v88, v88
  v_exp_f32 v89, v89
  v_exp_f32 v90, v90
  v_exp_f32 v91, v91
  v_mfma_f32_32x32x16_bf16 v[48:63], v[224:227], v[218:221], v[48:63]
  v_exp_f32 v92, v92
  v_exp_f32 v93, v93
  v_exp_f32 v94, v94
  v_exp_f32 v95, v95
  s_waitcnt lgkmcnt(0)
  ds_read_b64_tr_b16 v[236:237], v4 offset:0
  ds_read_b64_tr_b16 v[238:239], v4 offset:192
  ds_read_b64_tr_b16 v[240:241], v4 offset:768
  ds_read_b64_tr_b16 v[242:243], v4 offset:960
  v_smfmac_f32_32x32x32_bf16 v[152:167], v[244:247], v[80:87], v18
  v_exp_f32 v32, v32
  v_exp_f32 v33, v33
  v_exp_f32 v34, v34
  v_exp_f32 v35, v35
  v_smfmac_f32_32x32x32_bf16 v[152:167], v[248:251], v[88:95], v18
  v_exp_f32 v36, v36
  v_exp_f32 v37, v37
  v_exp_f32 v38, v38
  v_exp_f32 v39, v39
  v_mfma_f32_32x32x8_bf16 v[64:79], v[234:235], v[216:217], 0
  v_exp_f32 v40, v40
  v_exp_f32 v41, v41
  v_exp_f32 v42, v42
  v_exp_f32 v43, v43
  v_mfma_f32_32x32x16_bf16 v[64:79], v[230:233], v[212:215], v[64:79]
  v_exp_f32 v44, v44
  v_exp_f32 v45, v45
  v_exp_f32 v46, v46
  v_exp_f32 v47, v47
  s_setprio 2
  s_waitcnt lgkmcnt(0)
  v_add_u32 v11, 24576, v9
  s_waitcnt vmcnt(0)
  ds_write_b128 v11, v[96:99] offset:12288
  ds_write_b128 v11, v[100:103] offset:12304
  ds_write_b64 v11, v[104:105] offset:12320
  s_mov_b32 s43, 20480
  buffer_load_dwordx4 v[96:99], v8, s[36:39], s43 offen
  buffer_load_dwordx4 v[100:103], v8, s[36:39], s43 offen offset:16
  buffer_load_dwordx2 v[104:105], v8, s[36:39], s43 offen offset:32
  ds_read_b128 v[224:227], v2 offset:2048
  ds_read_b64 v[228:229], v3 offset:1024
  v_smfmac_f32_32x32x32_bf16 v[168:183], v[236:239], v[32:39], v18
  v_exp_f32 v48, v48
  v_exp_f32 v49, v49
  v_exp_f32 v50, v50
  v_exp_f32 v51, v51
  v_smfmac_f32_32x32x32_bf16 v[168:183], v[240:243], v[40:47], v18
  v_exp_f32 v52, v52
  v_exp_f32 v53, v53
  v_exp_f32 v54, v54
  v_exp_f32 v55, v55
  v_mfma_f32_32x32x8_bf16 v[80:95], v[234:235], v[222:223], 0
  v_exp_f32 v56, v56
  v_exp_f32 v57, v57
  v_exp_f32 v58, v58
  v_exp_f32 v59, v59
  v_mfma_f32_32x32x16_bf16 v[80:95], v[230:233], v[218:221], v[80:95]
  v_exp_f32 v60, v60
  v_exp_f32 v61, v61
  v_exp_f32 v62, v62
  v_exp_f32 v63, v63
  s_waitcnt lgkmcnt(0)
  ds_read_b64_tr_b16 v[244:245], v4 offset:3072
  ds_read_b64_tr_b16 v[246:247], v4 offset:3264
  ds_read_b64_tr_b16 v[248:249], v4 offset:3840
  ds_read_b64_tr_b16 v[250:251], v4 offset:4032
  v_smfmac_f32_32x32x32_bf16 v[184:199], v[236:239], v[48:55], v18
  v_exp_f32 v64, v64
  v_exp_f32 v65, v65
  v_exp_f32 v66, v66
  v_exp_f32 v67, v67
  v_smfmac_f32_32x32x32_bf16 v[184:199], v[240:243], v[56:63], v18
  v_exp_f32 v68, v68
  v_exp_f32 v69, v69
  v_exp_f32 v70, v70
  v_exp_f32 v71, v71
  v_mfma_f32_32x32x8_bf16 v[32:47], v[228:229], v[216:217], 0
  v_exp_f32 v72, v72
  v_exp_f32 v73, v73
  v_exp_f32 v74, v74
  v_exp_f32 v75, v75
  v_mfma_f32_32x32x16_bf16 v[32:47], v[224:227], v[212:215], v[32:47]
  v_exp_f32 v76, v76
  v_exp_f32 v77, v77
  v_exp_f32 v78, v78
  v_exp_f32 v79, v79
  s_setprio 1
  s_waitcnt lgkmcnt(0)
  ds_read_b128 v[230:233], v2 offset:3072
  ds_read_b64 v[234:235], v3 offset:1536
  v_smfmac_f32_32x32x32_bf16 v[168:183], v[244:247], v[64:71], v18
  v_exp_f32 v80, v80
  v_exp_f32 v81, v81
  v_exp_f32 v82, v82
  v_exp_f32 v83, v83
  v_smfmac_f32_32x32x32_bf16 v[168:183], v[248:251], v[72:79], v18
  v_exp_f32 v84, v84
  v_exp_f32 v85, v85
  v_exp_f32 v86, v86
  v_exp_f32 v87, v87
  v_mfma_f32_32x32x8_bf16 v[48:63], v[228:229], v[222:223], 0
  v_exp_f32 v88, v88
  v_exp_f32 v89, v89
  v_exp_f32 v90, v90
  v_exp_f32 v91, v91
  v_mfma_f32_32x32x16_bf16 v[48:63], v[224:227], v[218:221], v[48:63]
  v_exp_f32 v92, v92
  v_exp_f32 v93, v93
  v_exp_f32 v94, v94
  v_exp_f32 v95, v95
  s_waitcnt lgkmcnt(0)
  ds_read_b64_tr_b16 v[236:237], v4 offset:6144
  ds_read_b64_tr_b16 v[238:239], v4 offset:6336
  ds_read_b64_tr_b16 v[240:241], v4 offset:6912
  ds_read_b64_tr_b16 v[242:243], v4 offset:7104
  v_smfmac_f32_32x32x32_bf16 v[184:199], v[244:247], v[80:87], v18
  v_exp_f32 v32, v32
  v_exp_f32 v33, v33
  v_exp_f32 v34, v34
  v_exp_f32 v35, v35
  v_smfmac_f32_32x32x32_bf16 v[184:199], v[248:251], v[88:95], v18
  v_exp_f32 v36, v36
  v_exp_f32 v37, v37
  v_exp_f32 v38, v38
  v_exp_f32 v39, v39
  v_mfma_f32_32x32x8_bf16 v[64:79], v[234:235], v[216:217], 0
  v_exp_f32 v40, v40
  v_exp_f32 v41, v41
  v_exp_f32 v42, v42
  v_exp_f32 v43, v43
  v_mfma_f32_32x32x16_bf16 v[64:79], v[230:233], v[212:215], v[64:79]
  v_exp_f32 v44, v44
  v_exp_f32 v45, v45
  v_exp_f32 v46, v46
  v_exp_f32 v47, v47
  s_setprio 0
  s_waitcnt lgkmcnt(0)
  v_smfmac_f32_32x32x32_bf16 v[168:183], v[236:239], v[32:39], v18
  v_exp_f32 v48, v48
  v_exp_f32 v49, v49
  v_exp_f32 v50, v50
  v_exp_f32 v51, v51
  v_smfmac_f32_32x32x32_bf16 v[168:183], v[240:243], v[40:47], v18
  v_exp_f32 v52, v52
  v_exp_f32 v53, v53
  v_exp_f32 v54, v54
  v_exp_f32 v55, v55
  s_waitcnt lgkmcnt(0)
  s_barrier
  v_add_u32 v2, 24576, v5
  v_add_u32 v3, 24576, v6
  ds_read_b128 v[224:227], v2 offset:0
  ds_read_b64 v[228:229], v3 offset:0
  v_mfma_f32_32x32x8_bf16 v[80:95], v[234:235], v[222:223], 0
  v_exp_f32 v56, v56
  v_exp_f32 v57, v57
  v_exp_f32 v58, v58
  v_exp_f32 v59, v59
  v_mfma_f32_32x32x16_bf16 v[80:95], v[230:233], v[218:221], v[80:95]
  v_exp_f32 v60, v60
  v_exp_f32 v61, v61
  v_exp_f32 v62, v62
  v_exp_f32 v63, v63
  s_setprio 3
  s_waitcnt lgkmcnt(0)
  ds_read_b64_tr_b16 v[244:245], v4 offset:9216
  ds_read_b64_tr_b16 v[246:247], v4 offset:9408
  ds_read_b64_tr_b16 v[248:249], v4 offset:9984
  ds_read_b64_tr_b16 v[250:251], v4 offset:10176
  v_smfmac_f32_32x32x32_bf16 v[184:199], v[236:239], v[48:55], v18
  v_exp_f32 v64, v64
  v_exp_f32 v65, v65
  v_exp_f32 v66, v66
  v_exp_f32 v67, v67
  v_smfmac_f32_32x32x32_bf16 v[184:199], v[240:243], v[56:63], v18
  v_exp_f32 v68, v68
  v_exp_f32 v69, v69
  v_exp_f32 v70, v70
  v_exp_f32 v71, v71
  v_mfma_f32_32x32x8_bf16 v[32:47], v[228:229], v[204:205], 0
  v_exp_f32 v72, v72
  v_exp_f32 v73, v73
  v_exp_f32 v74, v74
  v_exp_f32 v75, v75
  v_mfma_f32_32x32x16_bf16 v[32:47], v[224:227], v[200:203], v[32:47]
  v_exp_f32 v76, v76
  v_exp_f32 v77, v77
  v_exp_f32 v78, v78
  v_exp_f32 v79, v79
  s_waitcnt lgkmcnt(0)
  v_add_u32 v4, 24576, v7
  ds_read_b64_tr_b16 v[236:237], v4 offset:0
  ds_read_b64_tr_b16 v[238:239], v4 offset:192
  ds_read_b64_tr_b16 v[240:241], v4 offset:768
  ds_read_b64_tr_b16 v[242:243], v4 offset:960
  v_smfmac_f32_32x32x32_bf16 v[168:183], v[244:247], v[64:71], v18
  v_exp_f32 v80, v80
  v_exp_f32 v81, v81
  v_exp_f32 v82, v82
  v_exp_f32 v83, v83
  v_smfmac_f32_32x32x32_bf16 v[168:183], v[248:251], v[72:79], v18
  v_exp_f32 v84, v84
  v_exp_f32 v85, v85
  v_exp_f32 v86, v86
  v_exp_f32 v87, v87
  v_mfma_f32_32x32x8_bf16 v[48:63], v[228:229], v[210:211], 0
  v_exp_f32 v88, v88
  v_exp_f32 v89, v89
  v_exp_f32 v90, v90
  v_exp_f32 v91, v91
  v_mfma_f32_32x32x16_bf16 v[48:63], v[224:227], v[206:209], v[48:63]
  v_exp_f32 v92, v92
  v_exp_f32 v93, v93
  v_exp_f32 v94, v94
  v_exp_f32 v95, v95
  s_mov_b32 s42, 0
  s_mov_b32 s44, 6
L_loop:
  s_waitcnt lgkmcnt(0)
  ds_read_b128 v[230:233], v2 offset:1024
  ds_read_b64 v[234:235], v3 offset:512
  v_smfmac_f32_32x32x32_bf16 v[184:199], v[244:247], v[80:87], v18
  v_exp_f32 v32, v32
  v_exp_f32 v33, v33
  v_exp_f32 v34, v34
  v_exp_f32 v35, v35
  v_smfmac_f32_32x32x32_bf16 v[184:199], v[248:251], v[88:95], v18
  v_exp_f32 v36, v36
  v_exp_f32 v37, v37
  v_exp_f32 v38, v38
  v_exp_f32 v39, v39
  v_mfma_f32_32x32x8_bf16 v[64:79], v[228:229], v[216:217], 0
  v_exp_f32 v40, v40
  v_exp_f32 v41, v41
  v_exp_f32 v42, v42
  v_exp_f32 v43, v43
  v_mfma_f32_32x32x16_bf16 v[64:79], v[224:227], v[212:215], v[64:79]
  v_exp_f32 v44, v44
  v_exp_f32 v45, v45
  v_exp_f32 v46, v46
  v_exp_f32 v47, v47
  s_setprio 2
  v_smfmac_f32_32x32x32_bf16 v[136:151], v[236:239], v[32:39], v18
  v_exp_f32 v48, v48
  v_exp_f32 v49, v49
  v_exp_f32 v50, v50
  v_exp_f32 v51, v51
  v_smfmac_f32_32x32x32_bf16 v[136:151], v[240:243], v[40:47], v18
  v_exp_f32 v52, v52
  v_exp_f32 v53, v53
  v_exp_f32 v54, v54
  v_exp_f32 v55, v55
  v_mfma_f32_32x32x8_bf16 v[80:95], v[228:229], v[222:223], 0
  v_exp_f32 v56, v56
  v_exp_f32 v57, v57
  v_exp_f32 v58, v58
  v_exp_f32 v59, v59
  v_mfma_f32_32x32x16_bf16 v[80:95], v[224:227], v[218:221], v[80:95]
  v_exp_f32 v60, v60
  v_exp_f32 v61, v61
  v_exp_f32 v62, v62
  v_exp_f32 v63, v63
  s_waitcnt lgkmcnt(0)
  ds_read_b64_tr_b16 v[244:245], v4 offset:3072
  ds_read_b64_tr_b16 v[246:247], v4 offset:3264
  ds_read_b64_tr_b16 v[248:249], v4 offset:3840
  ds_read_b64_tr_b16 v[250:251], v4 offset:4032
  v_smfmac_f32_32x32x32_bf16 v[152:167], v[236:239], v[48:55], v18
  v_exp_f32 v64, v64
  v_exp_f32 v65, v65
  v_exp_f32 v66, v66
  v_exp_f32 v67, v67
  v_smfmac_f32_32x32x32_bf16 v[152:167], v[240:243], v[56:63], v18
  v_exp_f32 v68, v68
  v_exp_f32 v69, v69
  v_exp_f32 v70, v70
  v_exp_f32 v71, v71
  v_mfma_f32_32x32x8_bf16 v[32:47], v[234:235], v[204:205], 0
  v_exp_f32 v72, v72
  v_exp_f32 v73, v73
  v_exp_f32 v74, v74
  v_exp_f32 v75, v75
  v_mfma_f32_32x32x16_bf16 v[32:47], v[230:233], v[200:203], v[32:47]
  v_exp_f32 v76, v76
  v_exp_f32 v77, v77
  v_exp_f32 v78, v78
  v_exp_f32 v79, v79
  v_smfmac_f32_32x32x32_bf16 v[168:183], v[236:239], v[64:71], v18
  v_exp_f32 v80, v80
  v_exp_f32 v81, v81
  v_exp_f32 v82, v82
  v_exp_f32 v83, v83
  v_smfmac_f32_32x32x32_bf16 v[168:183], v[240:243], v[72:79], v18
  v_exp_f32 v84, v84
  v_exp_f32 v85, v85
  v_exp_f32 v86, v86
  v_exp_f32 v87, v87
  v_mfma_f32_32x32x8_bf16 v[48:63], v[234:235], v[210:211], 0
  v_exp_f32 v88, v88
  v_exp_f32 v89, v89
  v_exp_f32 v90, v90
  v_exp_f32 v91, v91
  v_mfma_f32_32x32x16_bf16 v[48:63], v[230:233], v[206:209], v[48:63]
  v_exp_f32 v92, v92
  v_exp_f32 v93, v93
  v_exp_f32 v94, v94
  v_exp_f32 v95, v95
  s_waitcnt lgkmcnt(0)
  ds_read_b128 v[224:227], v2 offset:2048
  ds_read_b64 v[228:229], v3 offset:1024
  v_smfmac_f32_32x32x32_bf16 v[184:199], v[236:239], v[80:87], v18
  v_exp_f32 v32, v32
  v_exp_f32 v33, v33
  v_exp_f32 v34, v34
  v_exp_f32 v35, v35
  v_smfmac_f32_32x32x32_bf16 v[184:199], v[240:243], v[88:95], v18
  v_exp_f32 v36, v36
  v_exp_f32 v37, v37
  v_exp_f32 v38, v38
  v_exp_f32 v39, v39
  v_mfma_f32_32x32x8_bf16 v[64:79], v[234:235], v[216:217], 0
  v_exp_f32 v40, v40
  v_exp_f32 v41, v41
  v_exp_f32 v42, v42
  v_exp_f32 v43, v43
  v_mfma_f32_32x32x16_bf16 v[64:79], v[230:233], v[212:215], v[64:79]
  v_exp_f32 v44, v44
  v_exp_f32 v45, v45
  v_exp_f32 v46, v46
  v_exp_f32 v47, v47
  v_add_u32 v11, s42, v9
  v_add_u32 v12, s42, v10
  s_waitcnt vmcnt(0)
  s_cmp_lg_u32 s33, 0
  s_cbranch_scc1 L_stV1
  v_dot2_f32_bf16 v14, v96, v96, 0
  v_dot2_f32_bf16 v15, v97, v97, 0
  v_dot2_f32_bf16 v14, v98, v98, v14
  v_dot2_f32_bf16 v15, v99, v99, v15
  v_dot2_f32_bf16 v14, v100, v100, v14
  v_dot2_f32_bf16 v15, v101, v101, v15
  v_dot2_f32_bf16 v14, v102, v102, v14
  v_dot2_f32_bf16 v15, v103, v103, v15
  v_dot2_f32_bf16 v14, v104, v104, v14
  v_dot2_f32_bf16 v15, v105, v105, v15
  v_lshlrev_b32 v106, 16, v96
  v_and_b32 v107, 0xffff0000, v96
  v_lshlrev_b32 v108, 16, v97
  v_and_b32 v109, 0xffff0000, v97
  v_add_f32 v14, v14, v15
  v_sqrt_f32 v14, v14
  v_lshlrev_b32 v110, 16, v98
  v_and_b32 v111, 0xffff0000, v98
  v_lshlrev_b32 v112, 16, v99
  v_and_b32 v113, 0xffff0000, v99
  v_lshlrev_b32 v114, 16, v100
  v_and_b32 v115, 0xffff0000, v100
  v_add_f32 v14, 0x358637bd, v14
  v_rcp_f32 v16, v14
  v_lshlrev_b32 v116, 16, v101
  v_and_b32 v117, 0xffff0000, v101
  v_lshlrev_b32 v118, 16, v102
  v_and_b32 v119, 0xffff0000, v102
  v_lshlrev_b32 v120, 16, v103
  v_and_b32 v121, 0xffff0000, v103
  v_lshlrev_b32 v122, 16, v104
  v_and_b32 v123, 0xffff0000, v104
  v_lshlrev_b32 v124, 16, v105
  v_and_b32 v125, 0xffff0000, v105
  v_pk_mul_f32 v[106:107], v[106:107], v[16:17] op_sel_hi:[1,0]
  v_pk_mul_f32 v[108:109], v[108:109], v[16:17] op_sel_hi:[1,0]
  v_pk_mul_f32 v[110:111], v[110:111], v[16:17] op_sel_hi:[1,0]
  v_pk_mul_f32 v[112:113], v[112:113], v[16:17] op_sel_hi:[1,0]
  v_pk_mul_f32 v[114:115], v[114:115], v[16:17] op_sel_hi:[1,0]
  v_pk_mul_f32 v[116:117], v[116:117], v[16:17] op_sel_hi:[1,0]
  v_pk_mul_f32 v[118:119], v[118:119], v[16:17] op_sel_hi:[1,0]
  v_pk_mul_f32 v[120:121], v[120:121], v[16:17] op_sel_hi:[1,0]
  v_pk_mul_f32 v[122:123], v[122:123], v[16:17] op_sel_hi:[1,0]
  v_pk_mul_f32 v[124:125], v[124:125], v[16:17] op_sel_hi:[1,0]
  v_cvt_pk_bf16_f32 v96, v106, v107
  v_cvt_pk_bf16_f32 v97, v108, v109
  v_cvt_pk_bf16_f32 v98, v110, v111
  v_cvt_pk_bf16_f32 v99, v112, v113
  v_cvt_pk_bf16_f32 v100, v114, v115
  v_cvt_pk_bf16_f32 v101, v116, v117
  v_cvt_pk_bf16_f32 v102, v118, v119
  v_cvt_pk_bf16_f32 v103, v120, v121
  v_cvt_pk_bf16_f32 v104, v122, v123
  v_cvt_pk_bf16_f32 v105, v124, v125
  ds_write_b128 v11, v[96:99] offset:0
  ds_write_b128 v11, v[100:103] offset:4096
  ds_write_b64 v12, v[104:105] offset:8192
  s_branch L_stE1
L_stV1:
  ds_write_b128 v11, v[96:99] offset:12288
  ds_write_b128 v11, v[100:103] offset:12304
  ds_write_b64 v11, v[104:105] offset:12320
L_stE1:
  s_add_u32 s43, s43, 10240
  s_cmp_eq_u32 s44, 1
  s_cbranch_scc1 L_skipst
  buffer_load_dwordx4 v[96:99], v8, s[36:39], s43 offen
  buffer_load_dwordx4 v[100:103], v8, s[36:39], s43 offen offset:16
  buffer_load_dwordx2 v[104:105], v8, s[36:39], s43 offen offset:32
L_skipst:
  v_smfmac_f32_32x32x32_bf16 v[136:151], v[244:247], v[32:39], v18
  v_exp_f32 v48, v48
  v_exp_f32 v49, v49
  v_exp_f32 v50, v50
  v_exp_f32 v51, v51
  v_smfmac_f32_32x32x32_bf16 v[136:151], v[248:251], v[40:47], v18
  v_exp_f32 v52, v52
  v_exp_f32 v53, v53
  v_exp_f32 v54, v54
  v_exp_f32 v55, v55
  v_mfma_f32_32x32x8_bf16 v[80:95], v[234:235], v[222:223], 0
  v_exp_f32 v56, v56
  v_exp_f32 v57, v57
  v_exp_f32 v58, v58
  v_exp_f32 v59, v59
  v_mfma_f32_32x32x16_bf16 v[80:95], v[230:233], v[218:221], v[80:95]
  v_exp_f32 v60, v60
  v_exp_f32 v61, v61
  v_exp_f32 v62, v62
  v_exp_f32 v63, v63
  s_setprio 1
  s_waitcnt lgkmcnt(0)
  ds_read_b64_tr_b16 v[236:237], v4 offset:6144
  ds_read_b64_tr_b16 v[238:239], v4 offset:6336
  ds_read_b64_tr_b16 v[240:241], v4 offset:6912
  ds_read_b64_tr_b16 v[242:243], v4 offset:7104
  v_smfmac_f32_32x32x32_bf16 v[152:167], v[244:247], v[48:55], v18
  v_exp_f32 v64, v64
  v_exp_f32 v65, v65
  v_exp_f32 v66, v66
  v_exp_f32 v67, v67
  v_smfmac_f32_32x32x32_bf16 v[152:167], v[248:251], v[56:63], v18
  v_exp_f32 v68, v68
  v_exp_f32 v69, v69
  v_exp_f32 v70, v70
  v_exp_f32 v71, v71
  v_mfma_f32_32x32x8_bf16 v[32:47], v[228:229], v[204:205], 0
  v_exp_f32 v72, v72
  v_exp_f32 v73, v73
  v_exp_f32 v74, v74
  v_exp_f32 v75, v75
  v_mfma_f32_32x32x16_bf16 v[32:47], v[224:227], v[200:203], v[32:47]
  v_exp_f32 v76, v76
  v_exp_f32 v77, v77
  v_exp_f32 v78, v78
  v_exp_f32 v79, v79
  v_smfmac_f32_32x32x32_bf16 v[168:183], v[244:247], v[64:71], v18
  v_exp_f32 v80, v80
  v_exp_f32 v81, v81
  v_exp_f32 v82, v82
  v_exp_f32 v83, v83
  v_smfmac_f32_32x32x32_bf16 v[168:183], v[248:251], v[72:79], v18
  v_exp_f32 v84, v84
  v_exp_f32 v85, v85
  v_exp_f32 v86, v86
  v_exp_f32 v87, v87
  v_mfma_f32_32x32x8_bf16 v[48:63], v[228:229], v[210:211], 0
  v_exp_f32 v88, v88
  v_exp_f32 v89, v89
  v_exp_f32 v90, v90
  v_exp_f32 v91, v91
  v_mfma_f32_32x32x16_bf16 v[48:63], v[224:227], v[206:209], v[48:63]
  v_exp_f32 v92, v92
  v_exp_f32 v93, v93
  v_exp_f32 v94, v94
  v_exp_f32 v95, v95
  s_waitcnt lgkmcnt(0)
  ds_read_b128 v[230:233], v2 offset:3072
  ds_read_b64 v[234:235], v3 offset:1536
  v_smfmac_f32_32x32x32_bf16 v[184:199], v[244:247], v[80:87], v18
  v_exp_f32 v32, v32
  v_exp_f32 v33, v33
  v_exp_f32 v34, v34
  v_exp_f32 v35, v35
  v_smfmac_f32_32x32x32_bf16 v[184:199], v[248:251], v[88:95], v18
  v_exp_f32 v36, v36
  v_exp_f32 v37, v37
  v_exp_f32 v38, v38
  v_exp_f32 v39, v39
  v_mfma_f32_32x32x8_bf16 v[64:79], v[228:229], v[216:217], 0
  v_exp_f32 v40, v40
  v_exp_f32 v41, v41
  v_exp_f32 v42, v42
  v_exp_f32 v43, v43
  v_mfma_f32_32x32x16_bf16 v[64:79], v[224:227], v[212:215], v[64:79]
  v_exp_f32 v44, v44
  v_exp_f32 v45, v45
  v_exp_f32 v46, v46
  v_exp_f32 v47, v47
  v_smfmac_f32_32x32x32_bf16 v[136:151], v[236:239], v[32:39], v18
  v_exp_f32 v48, v48
  v_exp_f32 v49, v49
  v_exp_f32 v50, v50
  v_exp_f32 v51, v51
  v_smfmac_f32_32x32x32_bf16 v[136:151], v[240:243], v[40:47], v18
  v_exp_f32 v52, v52
  v_exp_f32 v53, v53
  v_exp_f32 v54, v54
  v_exp_f32 v55, v55
  v_mfma_f32_32x32x8_bf16 v[80:95], v[228:229], v[222:223], 0
  v_exp_f32 v56, v56
  v_exp_f32 v57, v57
  v_exp_f32 v58, v58
  v_exp_f32 v59, v59
  v_mfma_f32_32x32x16_bf16 v[80:95], v[224:227], v[218:221], v[80:95]
  v_exp_f32 v60, v60
  v_exp_f32 v61, v61
  v_exp_f32 v62, v62
  v_exp_f32 v63, v63
  s_waitcnt lgkmcnt(0)
  ds_read_b64_tr_b16 v[244:245], v4 offset:9216
  ds_read_b64_tr_b16 v[246:247], v4 offset:9408
  ds_read_b64_tr_b16 v[248:249], v4 offset:9984
  ds_read_b64_tr_b16 v[250:251], v4 offset:10176
  v_smfmac_f32_32x32x32_bf16 v[152:167], v[236:239], v[48:55], v18
  v_exp_f32 v64, v64
  v_exp_f32 v65, v65
  v_exp_f32 v66, v66
  v_exp_f32 v67, v67
  v_smfmac_f32_32x32x32_bf16 v[152:167], v[240:243], v[56:63], v18
  v_exp_f32 v68, v68
  v_exp_f32 v69, v69
  v_exp_f32 v70, v70
  v_exp_f32 v71, v71
  v_mfma_f32_32x32x8_bf16 v[32:47], v[234:235], v[204:205], 0
  v_exp_f32 v72, v72
  v_exp_f32 v73, v73
  v_exp_f32 v74, v74
  v_exp_f32 v75, v75
  v_mfma_f32_32x32x16_bf16 v[32:47], v[230:233], v[200:203], v[32:47]
  v_exp_f32 v76, v76
  v_exp_f32 v77, v77
  v_exp_f32 v78, v78
  v_exp_f32 v79, v79
  s_setprio 0
  v_smfmac_f32_32x32x32_bf16 v[168:183], v[236:239], v[64:71], v18
  v_exp_f32 v80, v80
  v_exp_f32 v81, v81
  v_exp_f32 v82, v82
  v_exp_f32 v83, v83
  v_smfmac_f32_32x32x32_bf16 v[168:183], v[240:243], v[72:79], v18
  v_exp_f32 v84, v84
  v_exp_f32 v85, v85
  v_exp_f32 v86, v86
  v_exp_f32 v87, v87
  v_mfma_f32_32x32x8_bf16 v[48:63], v[234:235], v[210:211], 0
  v_exp_f32 v88, v88
  v_exp_f32 v89, v89
  v_exp_f32 v90, v90
  v_exp_f32 v91, v91
  v_mfma_f32_32x32x16_bf16 v[48:63], v[230:233], v[206:209], v[48:63]
  v_exp_f32 v92, v92
  v_exp_f32 v93, v93
  v_exp_f32 v94, v94
  v_exp_f32 v95, v95
  s_waitcnt lgkmcnt(0)
  s_barrier
  v_add_u32 v2, s42, v5
  v_add_u32 v3, s42, v6
  ds_read_b128 v[224:227], v2 offset:0
  ds_read_b64 v[228:229], v3 offset:0
  s_setprio 3
  v_smfmac_f32_32x32x32_bf16 v[184:199], v[236:239], v[80:87], v18
  v_exp_f32 v32, v32
  v_exp_f32 v33, v33
  v_exp_f32 v34, v34
  v_exp_f32 v35, v35
  v_smfmac_f32_32x32x32_bf16 v[184:199], v[240:243], v[88:95], v18
  v_exp_f32 v36, v36
  v_exp_f32 v37, v37
  v_exp_f32 v38, v38
  v_exp_f32 v39, v39
  v_mfma_f32_32x32x8_bf16 v[64:79], v[234:235], v[216:217], 0
  v_exp_f32 v40, v40
  v_exp_f32 v41, v41
  v_exp_f32 v42, v42
  v_exp_f32 v43, v43
  v_mfma_f32_32x32x16_bf16 v[64:79], v[230:233], v[212:215], v[64:79]
  v_exp_f32 v44, v44
  v_exp_f32 v45, v45
  v_exp_f32 v46, v46
  v_exp_f32 v47, v47
  v_smfmac_f32_32x32x32_bf16 v[136:151], v[244:247], v[32:39], v18
  v_exp_f32 v48, v48
  v_exp_f32 v49, v49
  v_exp_f32 v50, v50
  v_exp_f32 v51, v51
  v_smfmac_f32_32x32x32_bf16 v[136:151], v[248:251], v[40:47], v18
  v_exp_f32 v52, v52
  v_exp_f32 v53, v53
  v_exp_f32 v54, v54
  v_exp_f32 v55, v55
  v_mfma_f32_32x32x8_bf16 v[80:95], v[234:235], v[222:223], 0
  v_exp_f32 v56, v56
  v_exp_f32 v57, v57
  v_exp_f32 v58, v58
  v_exp_f32 v59, v59
  v_mfma_f32_32x32x16_bf16 v[80:95], v[230:233], v[218:221], v[80:95]
  v_exp_f32 v60, v60
  v_exp_f32 v61, v61
  v_exp_f32 v62, v62
  v_exp_f32 v63, v63
  s_waitcnt lgkmcnt(0)
  v_add_u32 v4, s42, v7
  ds_read_b64_tr_b16 v[236:237], v4 offset:0
  ds_read_b64_tr_b16 v[238:239], v4 offset:192
  ds_read_b64_tr_b16 v[240:241], v4 offset:768
  ds_read_b64_tr_b16 v[242:243], v4 offset:960
  v_smfmac_f32_32x32x32_bf16 v[152:167], v[244:247], v[48:55], v18
  v_exp_f32 v64, v64
  v_exp_f32 v65, v65
  v_exp_f32 v66, v66
  v_exp_f32 v67, v67
  v_smfmac_f32_32x32x32_bf16 v[152:167], v[248:251], v[56:63], v18
  v_exp_f32 v68, v68
  v_exp_f32 v69, v69
  v_exp_f32 v70, v70
  v_exp_f32 v71, v71
  v_mfma_f32_32x32x8_bf16 v[32:47], v[228:229], v[204:205], 0
  v_exp_f32 v72, v72
  v_exp_f32 v73, v73
  v_exp_f32 v74, v74
  v_exp_f32 v75, v75
  v_mfma_f32_32x32x16_bf16 v[32:47], v[224:227], v[200:203], v[32:47]
  v_exp_f32 v76, v76
  v_exp_f32 v77, v77
  v_exp_f32 v78, v78
  v_exp_f32 v79, v79
  v_smfmac_f32_32x32x32_bf16 v[168:183], v[244:247], v[64:71], v18
  v_exp_f32 v80, v80
  v_exp_f32 v81, v81
  v_exp_f32 v82, v82
  v_exp_f32 v83, v83
  v_smfmac_f32_32x32x32_bf16 v[168:183], v[248:251], v[72:79], v18
  v_exp_f32 v84, v84
  v_exp_f32 v85, v85
  v_exp_f32 v86, v86
  v_exp_f32 v87, v87
  v_mfma_f32_32x32x8_bf16 v[48:63], v[228:229], v[210:211], 0
  v_exp_f32 v88, v88
  v_exp_f32 v89, v89
  v_exp_f32 v90, v90
  v_exp_f32 v91, v91
  v_mfma_f32_32x32x16_bf16 v[48:63], v[224:227], v[206:209], v[48:63]
  v_exp_f32 v92, v92
  v_exp_f32 v93, v93
  v_exp_f32 v94, v94
  v_exp_f32 v95, v95
  s_xor_b32 s42, s42, 24576
  s_sub_u32 s44, s44, 1
  s_cmp_lg_u32 s44, 0
  s_cbranch_scc1 L_loop
  s_waitcnt lgkmcnt(0)
  ds_read_b128 v[230:233], v2 offset:1024
  ds_read_b64 v[234:235], v3 offset:512
  v_smfmac_f32_32x32x32_bf16 v[184:199], v[244:247], v[80:87], v18
  v_exp_f32 v32, v32
  v_exp_f32 v33, v33
  v_exp_f32 v34, v34
  v_exp_f32 v35, v35
  v_smfmac_f32_32x32x32_bf16 v[184:199], v[248:251], v[88:95], v18
  v_exp_f32 v36, v36
  v_exp_f32 v37, v37
  v_exp_f32 v38, v38
  v_exp_f32 v39, v39
  s_waitcnt lgkmcnt(0)
  v_mfma_f32_32x32x8_bf16 v[64:79], v[234:235], v[204:205], 0
  v_exp_f32 v40, v40
  v_exp_f32 v41, v41
  v_exp_f32 v42, v42
  v_exp_f32 v43, v43
  v_mfma_f32_32x32x16_bf16 v[64:79], v[230:233], v[200:203], v[64:79]
  v_exp_f32 v44, v44
  v_exp_f32 v45, v45
  v_exp_f32 v46, v46
  v_exp_f32 v47, v47
  s_waitcnt lgkmcnt(0)
  ds_read_b128 v[224:227], v2 offset:2048
  ds_read_b64 v[228:229], v3 offset:1024
  v_smfmac_f32_32x32x32_bf16 v[136:151], v[236:239], v[32:39], v18
  v_exp_f32 v48, v48
  v_exp_f32 v49, v49
  v_exp_f32 v50, v50
  v_exp_f32 v51, v51
  v_smfmac_f32_32x32x32_bf16 v[136:151], v[240:243], v[40:47], v18
  v_exp_f32 v52, v52
  v_exp_f32 v53, v53
  v_exp_f32 v54, v54
  v_exp_f32 v55, v55
  v_mfma_f32_32x32x8_bf16 v[80:95], v[234:235], v[210:211], 0
  v_exp_f32 v56, v56
  v_exp_f32 v57, v57
  v_exp_f32 v58, v58
  v_exp_f32 v59, v59
  v_mfma_f32_32x32x16_bf16 v[80:95], v[230:233], v[206:209], v[80:95]
  v_exp_f32 v60, v60
  v_exp_f32 v61, v61
  v_exp_f32 v62, v62
  v_exp_f32 v63, v63
  s_waitcnt lgkmcnt(0)
  ds_read_b64_tr_b16 v[244:245], v4 offset:3072
  ds_read_b64_tr_b16 v[246:247], v4 offset:3264
  ds_read_b64_tr_b16 v[248:249], v4 offset:3840
  ds_read_b64_tr_b16 v[250:251], v4 offset:4032
  v_smfmac_f32_32x32x32_bf16 v[152:167], v[236:239], v[48:55], v18
  v_exp_f32 v64, v64
  v_exp_f32 v65, v65
  v_exp_f32 v66, v66
  v_exp_f32 v67, v67
  v_smfmac_f32_32x32x32_bf16 v[152:167], v[240:243], v[56:63], v18
  v_exp_f32 v68, v68
  v_exp_f32 v69, v69
  v_exp_f32 v70, v70
  v_exp_f32 v71, v71
  v_mfma_f32_32x32x8_bf16 v[32:47], v[228:229], v[204:205], 0
  v_exp_f32 v72, v72
  v_exp_f32 v73, v73
  v_exp_f32 v74, v74
  v_exp_f32 v75, v75
  v_mfma_f32_32x32x16_bf16 v[32:47], v[224:227], v[200:203], v[32:47]
  v_exp_f32 v76, v76
  v_exp_f32 v77, v77
  v_exp_f32 v78, v78
  v_exp_f32 v79, v79
  s_waitcnt lgkmcnt(0)
  ds_read_b128 v[230:233], v2 offset:3072
  ds_read_b64 v[234:235], v3 offset:1536
  v_smfmac_f32_32x32x32_bf16 v[136:151], v[244:247], v[64:71], v18
  v_exp_f32 v80, v80
  v_exp_f32 v81, v81
  v_exp_f32 v82, v82
  v_exp_f32 v83, v83
  v_smfmac_f32_32x32x32_bf16 v[136:151], v[248:251], v[72:79], v18
  v_exp_f32 v84, v84
  v_exp_f32 v85, v85
  v_exp_f32 v86, v86
  v_exp_f32 v87, v87
  v_mfma_f32_32x32x8_bf16 v[48:63], v[228:229], v[210:211], 0
  v_exp_f32 v88, v88
  v_exp_f32 v89, v89
  v_exp_f32 v90, v90
  v_exp_f32 v91, v91
  v_mfma_f32_32x32x16_bf16 v[48:63], v[224:227], v[206:209], v[48:63]
  v_exp_f32 v92, v92
  v_exp_f32 v93, v93
  v_exp_f32 v94, v94
  v_exp_f32 v95, v95
  s_setprio 2
  s_waitcnt lgkmcnt(0)
  ds_read_b64_tr_b16 v[236:237], v4 offset:6144
  ds_read_b64_tr_b16 v[238:239], v4 offset:6336
  ds_read_b64_tr_b16 v[240:241], v4 offset:6912
  ds_read_b64_tr_b16 v[242:243], v4 offset:7104
  v_smfmac_f32_32x32x32_bf16 v[152:167], v[244:247], v[80:87], v18
  v_exp_f32 v32, v32
  v_exp_f32 v33, v33
  v_exp_f32 v34, v34
  v_exp_f32 v35, v35
  v_smfmac_f32_32x32x32_bf16 v[152:167], v[248:251], v[88:95], v18
  v_exp_f32 v36, v36
  v_exp_f32 v37, v37
  v_exp_f32 v38, v38
  v_exp_f32 v39, v39
  v_mfma_f32_32x32x8_bf16 v[64:79], v[234:235], v[204:205], 0
  v_exp_f32 v40, v40
  v_exp_f32 v41, v41
  v_exp_f32 v42, v42
  v_exp_f32 v43, v43
  v_mfma_f32_32x32x16_bf16 v[64:79], v[230:233], v[200:203], v[64:79]
  v_exp_f32 v44, v44
  v_exp_f32 v45, v45
  v_exp_f32 v46, v46
  v_exp_f32 v47, v47
  s_waitcnt lgkmcnt(0)
  ds_read_b128 v[224:227], v2 offset:0
  ds_read_b64 v[228:229], v3 offset:0
  v_smfmac_f32_32x32x32_bf16 v[136:151], v[236:239], v[32:39], v18
  v_exp_f32 v48, v48
  v_exp_f32 v49, v49
  v_exp_f32 v50, v50
  v_exp_f32 v51, v51
  v_smfmac_f32_32x32x32_bf16 v[136:151], v[240:243], v[40:47], v18
  v_exp_f32 v52, v52
  v_exp_f32 v53, v53
  v_exp_f32 v54, v54
  v_exp_f32 v55, v55
  v_mfma_f32_32x32x8_bf16 v[80:95], v[234:235], v[210:211], 0
  v_exp_f32 v56, v56
  v_exp_f32 v57, v57
  v_exp_f32 v58, v58
  v_exp_f32 v59, v59
  v_mfma_f32_32x32x16_bf16 v[80:95], v[230:233], v[206:209], v[80:95]
  v_exp_f32 v60, v60
  v_exp_f32 v61, v61
  v_exp_f32 v62, v62
  v_exp_f32 v63, v63
  s_waitcnt lgkmcnt(0)
  ds_read_b64_tr_b16 v[244:245], v4 offset:9216
  ds_read_b64_tr_b16 v[246:247], v4 offset:9408
  ds_read_b64_tr_b16 v[248:249], v4 offset:9984
  ds_read_b64_tr_b16 v[250:251], v4 offset:10176
  v_smfmac_f32_32x32x32_bf16 v[152:167], v[236:239], v[48:55], v18
  v_exp_f32 v64, v64
  v_exp_f32 v65, v65
  v_exp_f32 v66, v66
  v_exp_f32 v67, v67
  v_smfmac_f32_32x32x32_bf16 v[152:167], v[240:243], v[56:63], v18
  v_exp_f32 v68, v68
  v_exp_f32 v69, v69
  v_exp_f32 v70, v70
  v_exp_f32 v71, v71
  v_mfma_f32_32x32x8_bf16 v[32:47], v[228:229], v[216:217], 0
  v_exp_f32 v72, v72
  v_exp_f32 v73, v73
  v_exp_f32 v74, v74
  v_exp_f32 v75, v75
  v_mfma_f32_32x32x16_bf16 v[32:47], v[224:227], v[212:215], v[32:47]
  v_exp_f32 v76, v76
  v_exp_f32 v77, v77
  v_exp_f32 v78, v78
  v_exp_f32 v79, v79
  s_waitcnt lgkmcnt(0)
  ds_read_b128 v[230:233], v2 offset:1024
  ds_read_b64 v[234:235], v3 offset:512
  v_smfmac_f32_32x32x32_bf16 v[136:151], v[244:247], v[64:71], v18
  v_exp_f32 v80, v80
  v_exp_f32 v81, v81
  v_exp_f32 v82, v82
  v_exp_f32 v83, v83
  v_smfmac_f32_32x32x32_bf16 v[136:151], v[248:251], v[72:79], v18
  v_exp_f32 v84, v84
  v_exp_f32 v85, v85
  v_exp_f32 v86, v86
  v_exp_f32 v87, v87
  v_mfma_f32_32x32x8_bf16 v[48:63], v[228:229], v[222:223], 0
  v_exp_f32 v88, v88
  v_exp_f32 v89, v89
  v_exp_f32 v90, v90
  v_exp_f32 v91, v91
  v_mfma_f32_32x32x16_bf16 v[48:63], v[224:227], v[218:221], v[48:63]
  v_exp_f32 v92, v92
  v_exp_f32 v93, v93
  v_exp_f32 v94, v94
  v_exp_f32 v95, v95
  s_setprio 0
  s_waitcnt lgkmcnt(0)
  ds_read_b64_tr_b16 v[236:237], v4 offset:0
  ds_read_b64_tr_b16 v[238:239], v4 offset:192
  ds_read_b64_tr_b16 v[240:241], v4 offset:768
  ds_read_b64_tr_b16 v[242:243], v4 offset:960
  v_smfmac_f32_32x32x32_bf16 v[152:167], v[244:247], v[80:87], v18
  v_exp_f32 v32, v32
  v_exp_f32 v33, v33
  v_exp_f32 v34, v34
  v_exp_f32 v35, v35
  v_smfmac_f32_32x32x32_bf16 v[152:167], v[248:251], v[88:95], v18
  ds_write_b128 v24, v[136:139] offset:0
  v_exp_f32 v36, v36
  ds_write_b128 v24, v[140:143] offset:1024
  v_exp_f32 v37, v37
  v_exp_f32 v38, v38
  ds_write_b128 v24, v[144:147] offset:2048
  v_exp_f32 v39, v39
  v_mfma_f32_32x32x8_bf16 v[64:79], v[234:235], v[216:217], 0
  v_exp_f32 v40, v40
  ds_write_b32 v25, v148 offset:3072
  v_exp_f32 v41, v41
  v_exp_f32 v42, v42
  v_exp_f32 v43, v43
  v_mfma_f32_32x32x16_bf16 v[64:79], v[230:233], v[212:215], v[64:79]
  v_exp_f32 v44, v44
  v_exp_f32 v45, v45
  v_exp_f32 v46, v46
  v_exp_f32 v47, v47
  s_setprio 3
  s_waitcnt lgkmcnt(0)
  s_barrier
  ds_read_b128 v[106:109], v26 offset:0
  ds_read_b128 v[110:113], v26 offset:1024
  ds_read_b128 v[114:117], v26 offset:2048
  ds_read_b32 v118, v27 offset:3072
  ds_read_b128 v[224:227], v2 offset:2048
  ds_read_b64 v[228:229], v3 offset:1024
  v_smfmac_f32_32x32x32_bf16 v[168:183], v[236:239], v[32:39], v18
  v_exp_f32 v48, v48
  v_exp_f32 v49, v49
  v_exp_f32 v50, v50
  v_exp_f32 v51, v51
  v_smfmac_f32_32x32x32_bf16 v[168:183], v[240:243], v[40:47], v18
  v_exp_f32 v52, v52
  v_exp_f32 v53, v53
  v_exp_f32 v54, v54
  v_exp_f32 v55, v55
  v_mfma_f32_32x32x8_bf16 v[80:95], v[234:235], v[222:223], 0
  v_exp_f32 v56, v56
  v_exp_f32 v57, v57
  v_exp_f32 v58, v58
  v_exp_f32 v59, v59
  v_mfma_f32_32x32x16_bf16 v[80:95], v[230:233], v[218:221], v[80:95]
  v_exp_f32 v60, v60
  v_exp_f32 v61, v61
  v_exp_f32 v62, v62
  v_exp_f32 v63, v63
  s_waitcnt lgkmcnt(0)
  ds_read_b64_tr_b16 v[244:245], v4 offset:3072
  ds_read_b64_tr_b16 v[246:247], v4 offset:3264
  ds_read_b64_tr_b16 v[248:249], v4 offset:3840
  ds_read_b64_tr_b16 v[250:251], v4 offset:4032
  ds_read_b128 v[230:233], v2 offset:3072
  ds_read_b64 v[234:235], v3 offset:1536
  v_smfmac_f32_32x32x32_bf16 v[184:199], v[236:239], v[48:55], v18
  v_exp_f32 v64, v64
  v_add_f32 v16, v164, v118
  v_exp_f32 v65, v65
  v_rcp_f32 v16, v16
  v_exp_f32 v66, v66
  v_pk_add_f32 v[106:107], v[106:107], v[152:153]
  v_exp_f32 v67, v67
  v_smfmac_f32_32x32x32_bf16 v[184:199], v[240:243], v[56:63], v18
  v_pk_add_f32 v[108:109], v[108:109], v[154:155]
  v_exp_f32 v68, v68
  v_pk_add_f32 v[110:111], v[110:111], v[156:157]
  v_exp_f32 v69, v69
  v_pk_add_f32 v[112:113], v[112:113], v[158:159]
  v_exp_f32 v70, v70
  v_pk_add_f32 v[114:115], v[114:115], v[160:161]
  v_exp_f32 v71, v71
  v_mfma_f32_32x32x8_bf16 v[32:47], v[228:229], v[216:217], 0
  v_exp_f32 v72, v72
  v_pk_add_f32 v[116:117], v[116:117], v[162:163]
  v_exp_f32 v73, v73
  v_pk_mul_f32 v[106:107], v[106:107], v[16:17] op_sel_hi:[1,0]
  v_exp_f32 v74, v74
  v_pk_mul_f32 v[108:109], v[108:109], v[16:17] op_sel_hi:[1,0]
  v_exp_f32 v75, v75
  v_mfma_f32_32x32x16_bf16 v[32:47], v[224:227], v[212:215], v[32:47]
  v_pk_mul_f32 v[110:111], v[110:111], v[16:17] op_sel_hi:[1,0]
  v_exp_f32 v76, v76
  v_pk_mul_f32 v[112:113], v[112:113], v[16:17] op_sel_hi:[1,0]
  v_exp_f32 v77, v77
  v_pk_mul_f32 v[114:115], v[114:115], v[16:17] op_sel_hi:[1,0]
  v_exp_f32 v78, v78
  v_exp_f32 v79, v79
  s_setprio 2
  s_waitcnt lgkmcnt(0)
  v_smfmac_f32_32x32x32_bf16 v[168:183], v[244:247], v[64:71], v18
  v_exp_f32 v80, v80
  v_pk_mul_f32 v[116:117], v[116:117], v[16:17] op_sel_hi:[1,0]
  v_exp_f32 v81, v81
  v_cvt_pk_bf16_f32 v106, v106, v107
  v_exp_f32 v82, v82
  v_cvt_pk_bf16_f32 v107, v108, v109
  v_exp_f32 v83, v83
  v_smfmac_f32_32x32x32_bf16 v[168:183], v[248:251], v[72:79], v18
  v_cvt_pk_bf16_f32 v108, v110, v111
  v_exp_f32 v84, v84
  v_cvt_pk_bf16_f32 v109, v112, v113
  v_exp_f32 v85, v85
  v_cvt_pk_bf16_f32 v110, v114, v115
  v_exp_f32 v86, v86
  v_cvt_pk_bf16_f32 v111, v116, v117
  v_exp_f32 v87, v87
  v_mfma_f32_32x32x8_bf16 v[48:63], v[234:235], v[216:217], 0
  v_exp_f32 v88, v88
  s_nop 1
  v_exp_f32 v89, v89
  v_permlane32_swap_b32 v106, v108
  v_exp_f32 v90, v90
  v_permlane32_swap_b32 v107, v109
  v_exp_f32 v91, v91
  v_mfma_f32_32x32x16_bf16 v[48:63], v[230:233], v[212:215], v[48:63]
  s_nop 1
  v_exp_f32 v92, v92
  buffer_store_dwordx4 v[106:109], v28, s[16:19], 0 offen offset:0 nt
  v_exp_f32 v93, v93
  buffer_store_dwordx2 v[110:111], v29, s[16:19], 0 offen offset:32 nt
  v_exp_f32 v94, v94
  v_exp_f32 v95, v95
  s_waitcnt lgkmcnt(0)
  ds_read_b64_tr_b16 v[236:237], v4 offset:6144
  ds_read_b64_tr_b16 v[238:239], v4 offset:6336
  ds_read_b64_tr_b16 v[240:241], v4 offset:6912
  ds_read_b64_tr_b16 v[242:243], v4 offset:7104
  v_smfmac_f32_32x32x32_bf16 v[184:199], v[244:247], v[80:87], v18
  v_exp_f32 v32, v32
  v_exp_f32 v33, v33
  v_exp_f32 v34, v34
  v_exp_f32 v35, v35
  v_smfmac_f32_32x32x32_bf16 v[184:199], v[248:251], v[88:95], v18
  v_exp_f32 v36, v36
  v_exp_f32 v37, v37
  v_exp_f32 v38, v38
  v_exp_f32 v39, v39
  v_mfma_f32_32x32x8_bf16 v[64:79], v[228:229], v[222:223], 0
  v_exp_f32 v40, v40
  v_exp_f32 v41, v41
  v_exp_f32 v42, v42
  v_exp_f32 v43, v43
  v_mfma_f32_32x32x16_bf16 v[64:79], v[224:227], v[218:221], v[64:79]
  v_exp_f32 v44, v44
  v_exp_f32 v45, v45
  v_exp_f32 v46, v46
  v_exp_f32 v47, v47
  s_setprio 1
  s_waitcnt lgkmcnt(0)
  ds_read_b64_tr_b16 v[244:245], v4 offset:9216
  ds_read_b64_tr_b16 v[246:247], v4 offset:9408
  ds_read_b64_tr_b16 v[248:249], v4 offset:9984
  ds_read_b64_tr_b16 v[250:251], v4 offset:10176
  v_smfmac_f32_32x32x32_bf16 v[168:183], v[236:239], v[32:39], v18
  v_exp_f32 v48, v48
  v_exp_f32 v49, v49
  v_exp_f32 v50, v50
  v_exp_f32 v51, v51
  v_smfmac_f32_32x32x32_bf16 v[168:183], v[240:243], v[40:47], v18
  v_exp_f32 v52, v52
  v_exp_f32 v53, v53
  v_exp_f32 v54, v54
  v_exp_f32 v55, v55
  v_mfma_f32_32x32x8_bf16 v[80:95], v[234:235], v[222:223], 0
  v_exp_f32 v56, v56
  v_exp_f32 v57, v57
  v_exp_f32 v58, v58
  v_exp_f32 v59, v59
  v_mfma_f32_32x32x16_bf16 v[80:95], v[230:233], v[218:221], v[80:95]
  v_exp_f32 v60, v60
  v_exp_f32 v61, v61
  v_exp_f32 v62, v62
  v_exp_f32 v63, v63
  s_waitcnt lgkmcnt(0)
  v_smfmac_f32_32x32x32_bf16 v[168:183], v[244:247], v[48:55], v18
  v_exp_f32 v64, v64
  v_exp_f32 v65, v65
  v_smfmac_f32_32x32x32_bf16 v[168:183], v[248:251], v[56:63], v18
  v_exp_f32 v66, v66
  v_exp_f32 v67, v67
  v_exp_f32 v68, v68
  v_exp_f32 v69, v69
  v_exp_f32 v70, v70
  v_exp_f32 v71, v71
  v_exp_f32 v72, v72
  v_exp_f32 v73, v73
  v_exp_f32 v74, v74
  v_exp_f32 v75, v75
  v_exp_f32 v76, v76
  v_exp_f32 v77, v77
  ds_write_b128 v24, v[168:171] offset:3328
  ds_write_b128 v24, v[172:175] offset:4352
  v_exp_f32 v78, v78
  ds_write_b128 v24, v[176:179] offset:5376
  v_exp_f32 v79, v79
  ds_write_b32 v25, v180 offset:6400
  s_setprio 0
  s_waitcnt lgkmcnt(0)
  s_barrier
  ds_read_b128 v[106:109], v26 offset:3328
  ds_read_b128 v[110:113], v26 offset:4352
  ds_read_b128 v[114:117], v26 offset:5376
  ds_read_b32 v118, v27 offset:6400
  v_smfmac_f32_32x32x32_bf16 v[184:199], v[236:239], v[64:71], v18
  v_exp_f32 v80, v80
  v_exp_f32 v81, v81
  v_smfmac_f32_32x32x32_bf16 v[184:199], v[240:243], v[72:79], v18
  v_exp_f32 v82, v82
  v_exp_f32 v83, v83
  v_exp_f32 v84, v84
  v_exp_f32 v85, v85
  v_exp_f32 v86, v86
  v_exp_f32 v87, v87
  v_exp_f32 v88, v88
  s_nop 1
  v_smfmac_f32_32x32x32_bf16 v[184:199], v[244:247], v[80:87], v18
  v_exp_f32 v89, v89
  v_exp_f32 v90, v90
  v_exp_f32 v91, v91
  v_exp_f32 v92, v92
  v_exp_f32 v93, v93
  v_exp_f32 v94, v94
  v_exp_f32 v95, v95
  s_nop 1
  v_smfmac_f32_32x32x32_bf16 v[184:199], v[248:251], v[88:95], v18
  s_waitcnt lgkmcnt(0)
  s_nop 7
  s_nop 3
  v_add_f32 v16, v196, v118
  v_rcp_f32 v16, v16
  v_pk_add_f32 v[106:107], v[106:107], v[184:185]
  v_pk_add_f32 v[108:109], v[108:109], v[186:187]
  v_pk_add_f32 v[110:111], v[110:111], v[188:189]
  v_pk_add_f32 v[112:113], v[112:113], v[190:191]
  v_pk_add_f32 v[114:115], v[114:115], v[192:193]
  v_pk_add_f32 v[116:117], v[116:117], v[194:195]
  v_pk_mul_f32 v[106:107], v[106:107], v[16:17] op_sel_hi:[1,0]
  v_pk_mul_f32 v[108:109], v[108:109], v[16:17] op_sel_hi:[1,0]
  v_pk_mul_f32 v[110:111], v[110:111], v[16:17] op_sel_hi:[1,0]
  v_pk_mul_f32 v[112:113], v[112:113], v[16:17] op_sel_hi:[1,0]
  v_pk_mul_f32 v[114:115], v[114:115], v[16:17] op_sel_hi:[1,0]
  v_pk_mul_f32 v[116:117], v[116:117], v[16:17] op_sel_hi:[1,0]
  v_cvt_pk_bf16_f32 v106, v106, v107
  v_cvt_pk_bf16_f32 v107, v108, v109
  v_cvt_pk_bf16_f32 v108, v110, v111
  v_cvt_pk_bf16_f32 v109, v112, v113
  v_cvt_pk_bf16_f32 v110, v114, v115
  v_cvt_pk_bf16_f32 v111, v116, v117
  s_nop 1
  v_permlane32_swap_b32 v106, v108
  v_permlane32_swap_b32 v107, v109
  s_nop 1
  buffer_store_dwordx4 v[106:109], v28, s[16:19], 0 offen offset:2560 nt
  buffer_store_dwordx2 v[110:111], v29, s[16:19], 0 offen offset:2592 nt
L_end:
  s_endpgm
L_fallback:
  s_cmp_eq_u32 s33, 0
  s_cbranch_scc1 L_fb_r0
  buffer_load_dwordx4 v[126:129], v13, s[4:7], 0 offen offset:2560
  buffer_load_dwordx4 v[130:133], v13, s[4:7], 0 offen offset:2576
  buffer_load_dwordx2 v[134:135], v13, s[4:7], 0 offen offset:2592
  s_waitcnt vmcnt(0)
  v_and_b32 v12, 0xc0, v0
  v_lshl_add_u32 v12, v12, 1, v1
  v_lshlrev_b32 v11, 4, v12
  v_lshl_add_u32 v12, v12, 3, s52
  v_dot2_f32_bf16 v14, v126, v126, 0
  v_dot2_f32_bf16 v15, v127, v127, 0
  v_dot2_f32_bf16 v14, v128, v128, v14
  v_dot2_f32_bf16 v15, v129, v129, v15
  v_dot2_f32_bf16 v14, v130, v130, v14
  v_dot2_f32_bf16 v15, v131, v131, v15
  v_dot2_f32_bf16 v14, v132, v132, v14
  v_dot2_f32_bf16 v15, v133, v133, v15
  v_dot2_f32_bf16 v14, v134, v134, v14
  v_dot2_f32_bf16 v15, v135, v135, v15
  v_lshlrev_b32 v106, 16, v126
  v_and_b32 v107, 0xffff0000, v126
  v_lshlrev_b32 v108, 16, v127
  v_and_b32 v109, 0xffff0000, v127
  v_add_f32 v14, v14, v15
  v_sqrt_f32 v14, v14
  v_lshlrev_b32 v110, 16, v128
  v_and_b32 v111, 0xffff0000, v128
  v_lshlrev_b32 v112, 16, v129
  v_and_b32 v113, 0xffff0000, v129
  v_lshlrev_b32 v114, 16, v130
  v_and_b32 v115, 0xffff0000, v130
  v_add_f32 v14, 0x358637bd, v14
  v_rcp_f32 v16, v14
  v_lshlrev_b32 v116, 16, v131
  v_and_b32 v117, 0xffff0000, v131
  v_lshlrev_b32 v118, 16, v132
  v_and_b32 v119, 0xffff0000, v132
  v_lshlrev_b32 v120, 16, v133
  v_and_b32 v121, 0xffff0000, v133
  v_lshlrev_b32 v122, 16, v134
  v_and_b32 v123, 0xffff0000, v134
  v_lshlrev_b32 v124, 16, v135
  v_and_b32 v125, 0xffff0000, v135
  v_mul_f32 v16, v16, v17
  s_nop 0
  v_pk_mul_f32 v[106:107], v[106:107], v[16:17] op_sel_hi:[1,0]
  v_pk_mul_f32 v[108:109], v[108:109], v[16:17] op_sel_hi:[1,0]
  v_pk_mul_f32 v[110:111], v[110:111], v[16:17] op_sel_hi:[1,0]
  v_pk_mul_f32 v[112:113], v[112:113], v[16:17] op_sel_hi:[1,0]
  v_pk_mul_f32 v[114:115], v[114:115], v[16:17] op_sel_hi:[1,0]
  v_pk_mul_f32 v[116:117], v[116:117], v[16:17] op_sel_hi:[1,0]
  v_pk_mul_f32 v[118:119], v[118:119], v[16:17] op_sel_hi:[1,0]
  v_pk_mul_f32 v[120:121], v[120:121], v[16:17] op_sel_hi:[1,0]
  v_pk_mul_f32 v[122:123], v[122:123], v[16:17] op_sel_hi:[1,0]
  v_pk_mul_f32 v[124:125], v[124:125], v[16:17] op_sel_hi:[1,0]
  v_cvt_pk_bf16_f32 v126, v106, v107
  v_cvt_pk_bf16_f32 v127, v108, v109
  v_cvt_pk_bf16_f32 v128, v110, v111
  v_cvt_pk_bf16_f32 v129, v112, v113
  v_cvt_pk_bf16_f32 v130, v114, v115
  v_cvt_pk_bf16_f32 v131, v116, v117
  v_cvt_pk_bf16_f32 v132, v118, v119
  v_cvt_pk_bf16_f32 v133, v120, v121
  v_cvt_pk_bf16_f32 v134, v122, v123
  v_cvt_pk_bf16_f32 v135, v124, v125
  ds_write_b128 v11, v[126:129] offset:50176
  ds_write_b128 v11, v[130:133] offset:58368
  ds_write_b64 v12, v[134:135] offset:512
  s_branch L_fb_skipH1
L_fb_r0:
  s_waitcnt vmcnt(0)
  v_dot2_f32_bf16 v14, v126, v126, 0
  v_dot2_f32_bf16 v15, v127, v127, 0
  v_dot2_f32_bf16 v14, v128, v128, v14
  v_dot2_f32_bf16 v15, v129, v129, v15
  v_dot2_f32_bf16 v14, v130, v130, v14
  v_dot2_f32_bf16 v15, v131, v131, v15
  v_lshlrev_b32 v106, 16, v126
  v_and_b32 v107, 0xffff0000, v126
  v_lshlrev_b32 v108, 16, v127
  v_and_b32 v109, 0xffff0000, v127
  v_add_f32 v16, v14, v15
  v_add_f32 v15, v14, v15
  v_lshlrev_b32 v110, 16, v128
  v_and_b32 v111, 0xffff0000, v128
  v_permlane32_swap_b32 v16, v15
  v_lshlrev_b32 v112, 16, v129
  v_and_b32 v113, 0xffff0000, v129
  v_add_f32 v14, v16, v15
  v_sqrt_f32 v14, v14
  v_lshlrev_b32 v114, 16, v130
  v_and_b32 v115, 0xffff0000, v130
  v_add_f32 v14, 0x358637bd, v14
  v_rcp_f32 v16, v14
  v_lshlrev_b32 v116, 16, v131
  v_and_b32 v117, 0xffff0000, v131
  v_mul_f32 v16, v16, v17
  s_nop 0
  v_pk_mul_f32 v[106:107], v[106:107], v[16:17] op_sel_hi:[1,0]
  v_pk_mul_f32 v[108:109], v[108:109], v[16:17] op_sel_hi:[1,0]
  v_pk_mul_f32 v[110:111], v[110:111], v[16:17] op_sel_hi:[1,0]
  v_pk_mul_f32 v[112:113], v[112:113], v[16:17] op_sel_hi:[1,0]
  v_pk_mul_f32 v[114:115], v[114:115], v[16:17] op_sel_hi:[1,0]
  v_pk_mul_f32 v[116:117], v[116:117], v[16:17] op_sel_hi:[1,0]
  v_cvt_pk_bf16_f32 v126, v106, v107
  v_cvt_pk_bf16_f32 v127, v108, v109
  v_cvt_pk_bf16_f32 v128, v110, v111
  v_cvt_pk_bf16_f32 v129, v112, v113
  v_cvt_pk_bf16_f32 v130, v114, v115
  v_cvt_pk_bf16_f32 v131, v116, v117
  ds_write_b128 v20, v[126:129]
  s_mov_b32 exec_hi, 0
  ds_write_b64 v22, v[130:131]
  s_mov_b32 exec_hi, -1
L_fb_skipH1:
  s_waitcnt vmcnt(0) lgkmcnt(0)
  s_barrier
  s_mov_b32 s43, 0
  s_mov_b32 s44, 8
  ds_read_b128 v[200:203], v20 offset:0
  ds_read_b64 v[204:205], v22 offset:0
  ds_read_b128 v[206:209], v21 offset:0
  ds_read_b64 v[210:211], v23 offset:0
  ds_read_b128 v[212:215], v20 offset:1024
  ds_read_b64 v[216:217], v22 offset:512
  ds_read_b128 v[218:221], v21 offset:1024
  ds_read_b64 v[222:223], v23 offset:512
  v_mov_b32 v13, 0xff800000
  v_mov_b32 v19, 0xff800000
  v_mov_b32 v2, 0xff800000
  v_mov_b32 v3, 0xff800000
  s_waitcnt lgkmcnt(0)
L_fb_chunk:
  buffer_load_dwordx4 v[96:99], v8, s[36:39], s43 offen
  buffer_load_dwordx4 v[100:103], v8, s[36:39], s43 offen offset:16
  buffer_load_dwordx2 v[104:105], v8, s[36:39], s43 offen offset:32
  v_add_u32 v11, 0, v9
  v_add_u32 v12, 0, v10
  s_waitcnt vmcnt(0)
  s_cmp_lg_u32 s33, 0
  s_cbranch_scc1 L_stV2
  v_dot2_f32_bf16 v14, v96, v96, 0
  v_dot2_f32_bf16 v15, v97, v97, 0
  v_dot2_f32_bf16 v14, v98, v98, v14
  v_dot2_f32_bf16 v15, v99, v99, v15
  v_dot2_f32_bf16 v14, v100, v100, v14
  v_dot2_f32_bf16 v15, v101, v101, v15
  v_dot2_f32_bf16 v14, v102, v102, v14
  v_dot2_f32_bf16 v15, v103, v103, v15
  v_dot2_f32_bf16 v14, v104, v104, v14
  v_dot2_f32_bf16 v15, v105, v105, v15
  v_lshlrev_b32 v106, 16, v96
  v_and_b32 v107, 0xffff0000, v96
  v_lshlrev_b32 v108, 16, v97
  v_and_b32 v109, 0xffff0000, v97
  v_add_f32 v14, v14, v15
  v_sqrt_f32 v14, v14
  v_lshlrev_b32 v110, 16, v98
  v_and_b32 v111, 0xffff0000, v98
  v_lshlrev_b32 v112, 16, v99
  v_and_b32 v113, 0xffff0000, v99
  v_lshlrev_b32 v114, 16, v100
  v_and_b32 v115, 0xffff0000, v100
  v_add_f32 v14, 0x358637bd, v14
  v_rcp_f32 v16, v14
  v_lshlrev_b32 v116, 16, v101
  v_and_b32 v117, 0xffff0000, v101
  v_lshlrev_b32 v118, 16, v102
  v_and_b32 v119, 0xffff0000, v102
  v_lshlrev_b32 v120, 16, v103
  v_and_b32 v121, 0xffff0000, v103
  v_lshlrev_b32 v122, 16, v104
  v_and_b32 v123, 0xffff0000, v104
  v_lshlrev_b32 v124, 16, v105
  v_and_b32 v125, 0xffff0000, v105
  v_pk_mul_f32 v[106:107], v[106:107], v[16:17] op_sel_hi:[1,0]
  v_pk_mul_f32 v[108:109], v[108:109], v[16:17] op_sel_hi:[1,0]
  v_pk_mul_f32 v[110:111], v[110:111], v[16:17] op_sel_hi:[1,0]
  v_pk_mul_f32 v[112:113], v[112:113], v[16:17] op_sel_hi:[1,0]
  v_pk_mul_f32 v[114:115], v[114:115], v[16:17] op_sel_hi:[1,0]
  v_pk_mul_f32 v[116:117], v[116:117], v[16:17] op_sel_hi:[1,0]
  v_pk_mul_f32 v[118:119], v[118:119], v[16:17] op_sel_hi:[1,0]
  v_pk_mul_f32 v[120:121], v[120:121], v[16:17] op_sel_hi:[1,0]
  v_pk_mul_f32 v[122:123], v[122:123], v[16:17] op_sel_hi:[1,0]
  v_pk_mul_f32 v[124:125], v[124:125], v[16:17] op_sel_hi:[1,0]
  v_cvt_pk_bf16_f32 v96, v106, v107
  v_cvt_pk_bf16_f32 v97, v108, v109
  v_cvt_pk_bf16_f32 v98, v110, v111
  v_cvt_pk_bf16_f32 v99, v112, v113
  v_cvt_pk_bf16_f32 v100, v114, v115
  v_cvt_pk_bf16_f32 v101, v116, v117
  v_cvt_pk_bf16_f32 v102, v118, v119
  v_cvt_pk_bf16_f32 v103, v120, v121
  v_cvt_pk_bf16_f32 v104, v122, v123
  v_cvt_pk_bf16_f32 v105, v124, v125
  ds_write_b128 v11, v[96:99] offset:0
  ds_write_b128 v11, v[100:103] offset:4096
  ds_write_b64 v12, v[104:105] offset:8192
  s_branch L_stE2
L_stV2:
  ds_write_b128 v11, v[96:99] offset:12288
  ds_write_b128 v11, v[100:103] offset:12304
  ds_write_b64 v11, v[104:105] offset:12320
L_stE2:
  s_waitcnt lgkmcnt(0)
  s_barrier
  v_and_b32 v14, 31, v1
  v_lshrrev_b32 v15, 5, v1
  v_lshlrev_b32 v4, 4, v14
  v_lshl_add_u32 v4, v15, 12, v4
  v_lshlrev_b32 v17, 3, v14
  v_lshl_add_u32 v17, v15, 11, v17
  v_add_u32 v17, 8192, v17
  s_mov_b32 s3, 8
L_fb_tile:
  ds_read_b128 v[224:227], v4 offset:0
  ds_read_b64 v[228:229], v17 offset:0
  s_waitcnt lgkmcnt(0)
  v_mfma_f32_32x32x8_bf16 v[32:47], v[228:229], v[204:205], 0
  v_mfma_f32_32x32x16_bf16 v[32:47], v[224:227], v[200:203], v[32:47]
  v_mfma_f32_32x32x8_bf16 v[48:63], v[228:229], v[210:211], 0
  v_mfma_f32_32x32x16_bf16 v[48:63], v[224:227], v[206:209], v[48:63]
  v_mfma_f32_32x32x8_bf16 v[64:79], v[228:229], v[216:217], 0
  v_mfma_f32_32x32x16_bf16 v[64:79], v[224:227], v[212:215], v[64:79]
  v_mfma_f32_32x32x8_bf16 v[80:95], v[228:229], v[222:223], 0
  v_mfma_f32_32x32x16_bf16 v[80:95], v[224:227], v[218:221], v[80:95]
  s_nop 7
  s_nop 7
  v_max3_f32 v13, v32, v33, v13
  v_max3_f32 v13, v34, v35, v13
  v_max3_f32 v13, v36, v37, v13
  v_max3_f32 v13, v38, v39, v13
  v_max3_f32 v13, v40, v41, v13
  v_max3_f32 v13, v42, v43, v13
  v_max3_f32 v13, v44, v45, v13
  v_max3_f32 v13, v46, v47, v13
  v_max3_f32 v19, v48, v49, v19
  v_max3_f32 v19, v50, v51, v19
  v_max3_f32 v19, v52, v53, v19
  v_max3_f32 v19, v54, v55, v19
  v_max3_f32 v19, v56, v57, v19
  v_max3_f32 v19, v58, v59, v19
  v_max3_f32 v19, v60, v61, v19
  v_max3_f32 v19, v62, v63, v19
  v_max3_f32 v2, v64, v65, v2
  v_max3_f32 v2, v66, v67, v2
  v_max3_f32 v2, v68, v69, v2
  v_max3_f32 v2, v70, v71, v2
  v_max3_f32 v2, v72, v73, v2
  v_max3_f32 v2, v74, v75, v2
  v_max3_f32 v2, v76, v77, v2
  v_max3_f32 v2, v78, v79, v2
  v_max3_f32 v3, v80, v81, v3
  v_max3_f32 v3, v82, v83, v3
  v_max3_f32 v3, v84, v85, v3
  v_max3_f32 v3, v86, v87, v3
  v_max3_f32 v3, v88, v89, v3
  v_max3_f32 v3, v90, v91, v3
  v_max3_f32 v3, v92, v93, v3
  v_max3_f32 v3, v94, v95, v3
  v_add_u32 v4, 512, v4
  v_add_u32 v17, 256, v17
  s_sub_u32 s3, s3, 1
  s_cmp_lg_u32 s3, 0
  s_cbranch_scc1 L_fb_tile
  s_barrier
  s_add_u32 s43, s43, 10240
  s_sub_u32 s44, s44, 1
  s_cmp_lg_u32 s44, 0
  s_cbranch_scc1 L_fb_chunk
  v_lshlrev_b32 v17, 3, v0
  v_add_u32 v17, 69632, v17
  ds_read_b32 v106, v17
  s_waitcnt lgkmcnt(0)
  v_lshlrev_b32 v106, 16, v106
  s_barrier
  v_mov_b32 v15, v13
  s_nop 1
  v_permlane32_swap_b32 v13, v15
  s_nop 1
  v_max_f32 v14, v13, v15
  v_sub_f32 v14, v106, v14
  v_cvt_pk_bf16_f32 v15, v14, 0
  v_lshlrev_b32 v16, 16, v15
  v_sub_f32 v16, v14, v16
  v_cvt_pk_bf16_f32 v108, v14, v16
  v_mov_b32 v109, 0
  v_or_b32 v110, 0x1000, v22
  ds_write_b64 v110, v[108:109] offset:0
  v_mov_b32 v15, v19
  s_nop 1
  v_permlane32_swap_b32 v19, v15
  s_nop 1
  v_max_f32 v14, v19, v15
  v_sub_f32 v14, v106, v14
  v_cvt_pk_bf16_f32 v15, v14, 0
  v_lshlrev_b32 v16, 16, v15
  v_sub_f32 v16, v14, v16
  v_cvt_pk_bf16_f32 v108, v14, v16
  v_mov_b32 v109, 0
  v_or_b32 v110, 0x1000, v23
  ds_write_b64 v110, v[108:109] offset:0
  v_mov_b32 v15, v2
  s_nop 1
  v_permlane32_swap_b32 v2, v15
  s_nop 1
  v_max_f32 v14, v2, v15
  v_sub_f32 v14, v106, v14
  v_cvt_pk_bf16_f32 v15, v14, 0
  v_lshlrev_b32 v16, 16, v15
  v_sub_f32 v16, v14, v16
  v_cvt_pk_bf16_f32 v108, v14, v16
  v_mov_b32 v109, 0
  v_or_b32 v110, 0x1000, v22
  ds_write_b64 v110, v[108:109] offset:512
  v_mov_b32 v15, v3
  s_nop 1
  v_permlane32_swap_b32 v3, v15
  s_nop 1
  v_max_f32 v14, v3, v15
  v_sub_f32 v14, v106, v14
  v_cvt_pk_bf16_f32 v15, v14, 0
  v_lshlrev_b32 v16, 16, v15
  v_sub_f32 v16, v14, v16
  v_cvt_pk_bf16_f32 v108, v14, v16
  v_mov_b32 v109, 0
  v_or_b32 v110, 0x1000, v23
  ds_write_b64 v110, v[108:109] offset:512
  s_mov_b32 s43, 0
  buffer_load_dwordx4 v[96:99], v8, s[36:39], s43 offen
  buffer_load_dwordx4 v[100:103], v8, s[36:39], s43 offen offset:16
  buffer_load_dwordx2 v[104:105], v8, s[36:39], s43 offen offset:32
  v_add_u32 v11, 0, v9
  v_add_u32 v12, 0, v10
  s_waitcnt vmcnt(0)
  s_cmp_lg_u32 s33, 0
  s_cbranch_scc1 L_stV3
  v_dot2_f32_bf16 v14, v96, v96, 0
  v_dot2_f32_bf16 v15, v97, v97, 0
  v_dot2_f32_bf16 v14, v98, v98, v14
  v_dot2_f32_bf16 v15, v99, v99, v15
  v_dot2_f32_bf16 v14, v100, v100, v14
  v_dot2_f32_bf16 v15, v101, v101, v15
  v_dot2_f32_bf16 v14, v102, v102, v14
  v_dot2_f32_bf16 v15, v103, v103, v15
  v_dot2_f32_bf16 v14, v104, v104, v14
  v_dot2_f32_bf16 v15, v105, v105, v15
  v_lshlrev_b32 v106, 16, v96
  v_and_b32 v107, 0xffff0000, v96
  v_lshlrev_b32 v108, 16, v97
  v_and_b32 v109, 0xffff0000, v97
  v_add_f32 v14, v14, v15
  v_sqrt_f32 v14, v14
  v_lshlrev_b32 v110, 16, v98
  v_and_b32 v111, 0xffff0000, v98
  v_lshlrev_b32 v112, 16, v99
  v_and_b32 v113, 0xffff0000, v99
  v_lshlrev_b32 v114, 16, v100
  v_and_b32 v115, 0xffff0000, v100
  v_add_f32 v14, 0x358637bd, v14
  v_rcp_f32 v16, v14
  v_lshlrev_b32 v116, 16, v101
  v_and_b32 v117, 0xffff0000, v101
  v_lshlrev_b32 v118, 16, v102
  v_and_b32 v119, 0xffff0000, v102
  v_lshlrev_b32 v120, 16, v103
  v_and_b32 v121, 0xffff0000, v103
  v_lshlrev_b32 v122, 16, v104
  v_and_b32 v123, 0xffff0000, v104
  v_lshlrev_b32 v124, 16, v105
  v_and_b32 v125, 0xffff0000, v105
  v_pk_mul_f32 v[106:107], v[106:107], v[16:17] op_sel_hi:[1,0]
  v_pk_mul_f32 v[108:109], v[108:109], v[16:17] op_sel_hi:[1,0]
  v_pk_mul_f32 v[110:111], v[110:111], v[16:17] op_sel_hi:[1,0]
  v_pk_mul_f32 v[112:113], v[112:113], v[16:17] op_sel_hi:[1,0]
  v_pk_mul_f32 v[114:115], v[114:115], v[16:17] op_sel_hi:[1,0]
  v_pk_mul_f32 v[116:117], v[116:117], v[16:17] op_sel_hi:[1,0]
  v_pk_mul_f32 v[118:119], v[118:119], v[16:17] op_sel_hi:[1,0]
  v_pk_mul_f32 v[120:121], v[120:121], v[16:17] op_sel_hi:[1,0]
  v_pk_mul_f32 v[122:123], v[122:123], v[16:17] op_sel_hi:[1,0]
  v_pk_mul_f32 v[124:125], v[124:125], v[16:17] op_sel_hi:[1,0]
  v_cvt_pk_bf16_f32 v96, v106, v107
  v_cvt_pk_bf16_f32 v97, v108, v109
  v_cvt_pk_bf16_f32 v98, v110, v111
  v_cvt_pk_bf16_f32 v99, v112, v113
  v_cvt_pk_bf16_f32 v100, v114, v115
  v_cvt_pk_bf16_f32 v101, v116, v117
  v_cvt_pk_bf16_f32 v102, v118, v119
  v_cvt_pk_bf16_f32 v103, v120, v121
  v_cvt_pk_bf16_f32 v104, v122, v123
  v_cvt_pk_bf16_f32 v105, v124, v125
  ds_write_b128 v11, v[96:99] offset:0
  ds_write_b128 v11, v[100:103] offset:4096
  ds_write_b64 v12, v[104:105] offset:8192
  s_branch L_stE3
L_stV3:
  ds_write_b128 v11, v[96:99] offset:12288
  ds_write_b128 v11, v[100:103] offset:12304
  ds_write_b64 v11, v[104:105] offset:12320
L_stE3:
  v_and_b32 v13, 0xc0, v0
  v_lshl_add_u32 v13, v13, 1, v1
  v_mul_u32_u24 v13, 40, v13
  s_cmp_eq_u32 s33, 0
  s_cbranch_scc1 L_fb_r0l
  s_branch L_fb_skipH1l
L_fb_r0l:
  buffer_load_dwordx4 v[126:129], v28, s[4:7], 0 offen offset:1280
  buffer_load_dwordx2 v[130:131], v29, s[4:7], 0 offen offset:1312
L_fb_skipH1l:
  v_mov_b32 v17, s34
  v_mul_f32 v17, 0x3fb8aa3b, v17
  v_mov_b32 v2, v5
  v_mov_b32 v3, v6
  v_mov_b32 v4, v7
  s_waitcnt lgkmcnt(0)
  s_barrier
  s_cmp_eq_u32 s33, 0
  s_cbranch_scc1 L_go0
  s_branch L_go1

.section .rodata,"a"
.p2align 6
.amdhsa_kernel standalone__qk_norm__prompt_kernel
  .amdhsa_next_free_vgpr 252
  .amdhsa_next_free_sgpr 102
  .amdhsa_accum_offset 252
  .amdhsa_group_segment_fixed_size 0
  .amdhsa_kernarg_size 56
  .amdhsa_user_sgpr_count 2
  .amdhsa_user_sgpr_kernarg_segment_ptr 1
  .amdhsa_system_sgpr_workgroup_id_x 1
.end_amdhsa_kernel
```
